```python
import torch

def _softmax(x, axis=-1):
    return torch.softmax(x, dim=axis)
def _gelu(x):
    return torch.nn.functional.gelu(x, approximate="tanh")
def _silu(x):
    return torch.nn.functional.silu(x)
def _sigmoid(x):
    return torch.sigmoid(x)
def _layernorm(x, axis=-1, eps=1e-5):
    m = x.mean(dim=axis, keepdim=True)
    v = x.var(dim=axis, keepdim=True, unbiased=False)
    return (x - m) / torch.sqrt(v + eps)
def _scatter_add(tgt, idx, src, axis=0):
    return tgt.clone().index_add_(axis, idx, src)
def _segment_sum(src, seg, n):
    out = torch.zeros((n,) + src.shape[1:], dtype=src.dtype)
    return out.index_add_(0, seg, src)
def _pad(x, pw):
    flat = tuple(v for pair in reversed(pw) for v in pair)
    return torch.nn.functional.pad(x, flat)

kernel_name = 'gated_mix__linear_attn_block__sliding_block__prompt'

def setup_inputs():

    _w = (lambda a: (lambda t: t.to(torch.bfloat16) if t.is_floating_point() else t)(torch.as_tensor(a)))
    def _A_setup():
        B, S, D = 1, 2048, 448
        return {
            "x": _w((lambda *s: torch.randn(*s, dtype=torch.bfloat16) * 0.05)(B, S, D)),
            "wqkv": _w((lambda *s: torch.randn(*s, dtype=torch.bfloat16) * 1.6)(D, 3 * D)),
            "wo": _w((lambda *s: torch.randn(*s, dtype=torch.bfloat16) * 0.8)(D, D)),
        }
    _A_in = _A_setup()

    def _B_setup():
        B, S, D = 1, 2048, 448
        return {
            "x": _w((lambda *s: torch.randn(*s, dtype=torch.bfloat16) * 0.05)(B, S, D)),
            "wqkv": _w((lambda *s: torch.randn(*s, dtype=torch.bfloat16) * 1.6)(D, 3 * D)),
            "wo": _w((lambda *s: torch.randn(*s, dtype=torch.bfloat16) * 0.05)(D, D)),
        }
    _B_in = _B_setup()

    return {
        "A_x": _A_in["x"],
        "A_wqkv": _A_in["wqkv"],
        "A_wo": _A_in["wo"],
        "B_x": _B_in["x"],
        "B_wqkv": _B_in["wqkv"],
        "B_wo": _B_in["wo"],
        "gate_w": _w((lambda *s: torch.randn(*s, dtype=torch.bfloat16) * 0.05)(448) * 16.0),
    }

def reference(A_x, A_wqkv, A_wo, B_x, B_wqkv, B_wo, gate_w):
    def _A_ref(x, wqkv, wo):
        B, S, D = x.shape
        H = 16; Dh = D // H
        qkv = (lambda x, *d: x.permute(*d))((x @ wqkv).reshape(B, S, 3, H, Dh), 2, 0, 3, 1, 4)
        q, k, v = qkv[0], qkv[1], qkv[2]
        phi = lambda t: torch.where(t > 0, t + 1, torch.exp(t)) + 1e-6
        pq, pk = phi(q), phi(k)
        kv = torch.einsum("bhsd,bhse->bhde", pk, v)
        z = torch.einsum("bhsd->bhd", pk)
        num = torch.einsum("bhqd,bhde->bhqe", pq, kv)
        den = torch.einsum("bhqd,bhd->bhq", pq, z)[..., None] + 1e-6
        o = num / den
        return (lambda x, *d: x.permute(*d))(o, 0, 2, 1, 3).reshape(B, S, D) @ wo

    def _B_ref(x, wqkv, wo):
        B, S, D = x.shape
        H = 16; Dh = D // H; W = 256
        qkv = (lambda x, *d: x.permute(*d))((x @ wqkv).reshape(B, S, 3, H, Dh), 2, 0, 3, 1, 4)
        q, k, v = qkv[0], qkv[1], qkv[2]
        scores = torch.einsum("bhqd,bhkd->bhqk", q, k) * (Dh ** -0.5)
        idx = torch.arange(S)
        mask = (idx[:, None] - idx[None, :] >= 0) & (idx[:, None] - idx[None, :] < W)
        scores = torch.where(mask[None, None], scores, -1e9)
        p = _softmax(scores, axis=-1)
        o = torch.einsum("bhqk,bhkd->bhqd", p, v)
        return (lambda x, *d: x.permute(*d))(o, 0, 2, 1, 3).reshape(B, S, D) @ wo

    x = A_x
    g = _sigmoid((x * gate_w).sum(-1, keepdims=True))
    a = _A_ref(x, A_wqkv, A_wo)
    b = _B_ref(x, B_wqkv, B_wo)
    return g * a + (1 - g) * b
```

```asm
; @launch grid=(256,1,1) block=(512,1,1) lds=163840
.amdgcn_target "amdgcn-amd-amdhsa--gfx950"
.text
.globl gated_mix__linear_attn_block__sliding_block__prompt_kernel
.p2align 8
.type gated_mix__linear_attn_block__sliding_block__prompt_kernel,@function
gated_mix__linear_attn_block__sliding_block__prompt_kernel:
    s_cmp_ge_u32 s2, 256
    s_cbranch_scc1 L_end
    s_load_dwordx16 s[64:79], s[0:1], 0
    s_load_dwordx4 s[80:83], s[0:1], 64
    v_lshrrev_b32 v3, 6, v0
    v_and_b32 v1, 63, v0
    v_readfirstlane_b32 s24, v3
    v_lshlrev_b32 v2, 4, v1
    s_bfe_u32 s21, s2, 0x10005
    s_bfe_u32 s22, s2, 0x20001
    s_lshl_b32 s22, s22, 2
    s_lshr_b32 s48, s2, 6
    s_add_u32 s22, s22, s48
    s_and_b32 s23, s2, 1
    s_lshl_b32 s23, s23, 2
    s_bfe_u32 s48, s2, 0x20003
    s_add_u32 s23, s23, s48
    s_and_b32 s20, s24, 3
    s_cmp_lt_u32 s24, 4
    s_cbranch_scc1 L_compute
    v_lshrrev_b32 v3, 3, v1
    v_mul_u32_u24 v3, 896, v3
    v_and_b32 v4, 7, v1
    v_lshrrev_b32 v5, 4, v1
    v_xor_b32 v5, v4, v5
    v_lshl_add_u32 v12, v5, 4, v3
    v_xor_b32 v5, 4, v5
    v_lshl_add_u32 v13, v5, 4, v3
    v_mul_u32_u24 v3, 37, v1
    v_lshrrev_b32 v3, 8, v3
    v_mul_u32_u24 v4, 7, v3
    v_sub_u32 v4, v1, v4
    v_and_b32 v5, 3, v3
    v_lshlrev_b32 v5, 2, v5
    v_lshrrev_b32 v3, 2, v3
    v_add_u32 v5, v5, v3
    v_mul_u32_u24 v5, 2688, v5
    v_lshl_add_u32 v14, v4, 4, v5
    s_mov_b32 s28, -1
    s_mov_b32 s29, 0xffffff
    s_lshr_b32 s46, s2, 6
    s_lshl_b32 s46, s46, 1
    s_bfe_u32 s54, s2, 0x30003
    s_add_u32 s54, s46, s54
    s_sub_u32 s46, s54, 7
    s_cmp_ge_u32 s54, 7
    s_cselect_b32 s54, s46, s54
    s_mov_b32 s34, s54
    s_mov_b32 s60, 0
    s_lshl_b32 s46, s22, 2
    s_add_u32 s46, s46, s20
    s_mul_i32 s61, s46, 28672
    s_mul_i32 s25, s20, 43008
    s_mul_i32 s46, s23, 112
    s_add_u32 s25, s25, s46
    s_lshl_b32 s26, s20, 12
    s_add_u32 s26, s26, 35840
    s_mul_i32 s35, s20, 1792
    s_add_u32 s27, s35, 101376
    s_lshl_b32 s55, s54, 7
    s_add_u32 s55, s55, s61
    s_mul_i32 s56, s54, 172032
    s_add_u32 s56, s56, s25
    s_lshl_b32 s57, s60, 14
    s_add_u32 s57, s57, s26
    s_mul_i32 s58, s60, 14336
    s_add_u32 s58, s58, s27
    s_waitcnt lgkmcnt(0)
    s_mov_b32 s4, s64
    s_and_b32 s5, s65, 0xffff
    s_mov_b32 s6, 1835008
    s_mov_b32 s7, 0x20000
    s_cmp_eq_u32 s21, 0
    s_cselect_b32 s46, s66, s72
    s_cselect_b32 s47, s67, s73
    s_mov_b32 s8, s46
    s_and_b32 s9, s47, 0xffff
    s_mov_b32 s10, 1204224
    s_mov_b32 s11, 0x20000
    s_add_u32 m0, s57, 0
    s_add_u32 s49, s55, 0
    buffer_load_dwordx4 v12, s[4:7], s49 offen lds
    s_add_u32 m0, s57, 1024
    s_add_u32 s49, s55, 7168
    buffer_load_dwordx4 v13, s[4:7], s49 offen lds
    s_add_u32 m0, s57, 2048
    s_add_u32 s49, s55, 14336
    buffer_load_dwordx4 v12, s[4:7], s49 offen lds
    s_add_u32 m0, s57, 3072
    s_add_u32 s49, s55, 21504
    buffer_load_dwordx4 v13, s[4:7], s49 offen lds
    s_mov_b64 exec, s[28:29]
    s_add_u32 m0, s58, 0
    s_add_u32 s49, s56, 896
    buffer_load_dwordx4 v14, s[8:11], s49 offen lds
    s_add_u32 m0, s58, 896
    s_add_u32 s49, s56, 6272
    buffer_load_dwordx4 v14, s[8:11], s49 offen lds
    s_add_u32 m0, s58, 7168
    s_add_u32 s49, s56, 1792
    buffer_load_dwordx4 v14, s[8:11], s49 offen lds
    s_add_u32 m0, s58, 8064
    s_add_u32 s49, s56, 7168
    buffer_load_dwordx4 v14, s[8:11], s49 offen lds
    s_mov_b64 exec, -1
    s_add_u32 s54, s54, 1
    s_cmp_eq_u32 s54, 7
    s_cselect_b32 s54, 0, s54
    s_add_u32 s60, s60, 1
    s_and_b32 s60, s60, 3
    s_lshl_b32 s55, s54, 7
    s_add_u32 s55, s55, s61
    s_mul_i32 s56, s54, 172032
    s_add_u32 s56, s56, s25
    s_lshl_b32 s57, s60, 14
    s_add_u32 s57, s57, s26
    s_mul_i32 s58, s60, 14336
    s_add_u32 s58, s58, s27
    s_mov_b32 s16, s76
    s_and_b32 s17, s77, 0xffff
    s_mov_b32 s18, 896
    s_mov_b32 s19, 0x20000
    s_mov_b32 s12, s82
    s_and_b32 s13, s83, 0xffff
    s_mov_b32 s14, 13631488
    s_mov_b32 s15, 0x20000
    s_mov_b32 s96, s80
    s_and_b32 s97, s81, 0xffff
    s_mov_b32 s98, 256
    s_mov_b32 s99, 0x20000
    s_mov_b32 s40, s78
    s_mov_b32 s41, s79
    s_lshl_b32 s50, s21, 3
    s_add_u32 s50, s50, s23
    s_lshl_b32 s51, s22, 1
    s_lshr_b32 s52, s23, 2
    s_add_u32 s51, s51, s52
    s_bfe_u32 s52, s2, 0x30003
    s_add_u32 m0, s57, 0
    s_add_u32 s49, s55, 0
    buffer_load_dwordx4 v12, s[4:7], s49 offen lds
    s_add_u32 m0, s57, 1024
    s_add_u32 s49, s55, 7168
    buffer_load_dwordx4 v13, s[4:7], s49 offen lds
    s_add_u32 m0, s57, 2048
    s_add_u32 s49, s55, 14336
    buffer_load_dwordx4 v12, s[4:7], s49 offen lds
    s_add_u32 m0, s57, 3072
    s_add_u32 s49, s55, 21504
    buffer_load_dwordx4 v13, s[4:7], s49 offen lds
    s_mov_b64 exec, s[28:29]
    s_add_u32 m0, s58, 0
    s_add_u32 s49, s56, 896
    buffer_load_dwordx4 v14, s[8:11], s49 offen lds
    s_add_u32 m0, s58, 896
    s_add_u32 s49, s56, 6272
    buffer_load_dwordx4 v14, s[8:11], s49 offen lds
    s_add_u32 m0, s58, 7168
    s_add_u32 s49, s56, 1792
    buffer_load_dwordx4 v14, s[8:11], s49 offen lds
    s_add_u32 m0, s58, 8064
    s_add_u32 s49, s56, 7168
    buffer_load_dwordx4 v14, s[8:11], s49 offen lds
    s_mov_b64 exec, -1
    s_add_u32 s54, s54, 1
    s_cmp_eq_u32 s54, 7
    s_cselect_b32 s54, 0, s54
    s_add_u32 s60, s60, 1
    s_and_b32 s60, s60, 3
    s_lshl_b32 s55, s54, 7
    s_add_u32 s55, s55, s61
    s_mul_i32 s56, s54, 172032
    s_add_u32 s56, s56, s25
    s_lshl_b32 s57, s60, 14
    s_add_u32 s57, s57, s26
    s_mul_i32 s58, s60, 14336
    s_add_u32 s58, s58, s27
    s_waitcnt vmcnt(8)
    s_barrier
    s_add_u32 m0, s57, 0
    s_add_u32 s49, s55, 0
    buffer_load_dwordx4 v12, s[4:7], s49 offen lds
    s_add_u32 m0, s57, 1024
    s_add_u32 s49, s55, 7168
    buffer_load_dwordx4 v13, s[4:7], s49 offen lds
    s_add_u32 m0, s57, 2048
    s_add_u32 s49, s55, 14336
    buffer_load_dwordx4 v12, s[4:7], s49 offen lds
    s_add_u32 m0, s57, 3072
    s_add_u32 s49, s55, 21504
    buffer_load_dwordx4 v13, s[4:7], s49 offen lds
    s_mov_b64 exec, s[28:29]
    s_add_u32 m0, s58, 0
    s_add_u32 s49, s56, 896
    buffer_load_dwordx4 v14, s[8:11], s49 offen lds
    s_add_u32 m0, s58, 896
    s_add_u32 s49, s56, 6272
    buffer_load_dwordx4 v14, s[8:11], s49 offen lds
    s_add_u32 m0, s58, 7168
    s_add_u32 s49, s56, 1792
    buffer_load_dwordx4 v14, s[8:11], s49 offen lds
    s_add_u32 m0, s58, 8064
    s_add_u32 s49, s56, 7168
    buffer_load_dwordx4 v14, s[8:11], s49 offen lds
    s_mov_b64 exec, -1
    s_add_u32 s54, s54, 1
    s_cmp_eq_u32 s54, 7
    s_cselect_b32 s54, 0, s54
    s_add_u32 s60, s60, 1
    s_and_b32 s60, s60, 3
    s_lshl_b32 s55, s54, 7
    s_add_u32 s55, s55, s61
    s_mul_i32 s56, s54, 172032
    s_add_u32 s56, s56, s25
    s_lshl_b32 s57, s60, 14
    s_add_u32 s57, s57, s26
    s_mul_i32 s58, s60, 14336
    s_add_u32 s58, s58, s27
    s_waitcnt vmcnt(8)
    s_barrier
    s_add_u32 m0, s57, 0
    s_add_u32 s49, s55, 0
    buffer_load_dwordx4 v12, s[4:7], s49 offen lds
    s_add_u32 m0, s57, 1024
    s_add_u32 s49, s55, 7168
    buffer_load_dwordx4 v13, s[4:7], s49 offen lds
    s_add_u32 m0, s57, 2048
    s_add_u32 s49, s55, 14336
    buffer_load_dwordx4 v12, s[4:7], s49 offen lds
    s_add_u32 m0, s57, 3072
    s_add_u32 s49, s55, 21504
    buffer_load_dwordx4 v13, s[4:7], s49 offen lds
    s_mov_b64 exec, s[28:29]
    s_add_u32 m0, s58, 0
    s_add_u32 s49, s56, 896
    buffer_load_dwordx4 v14, s[8:11], s49 offen lds
    s_add_u32 m0, s58, 896
    s_add_u32 s49, s56, 6272
    buffer_load_dwordx4 v14, s[8:11], s49 offen lds
    s_add_u32 m0, s58, 7168
    s_add_u32 s49, s56, 1792
    buffer_load_dwordx4 v14, s[8:11], s49 offen lds
    s_add_u32 m0, s58, 8064
    s_add_u32 s49, s56, 7168
    buffer_load_dwordx4 v14, s[8:11], s49 offen lds
    s_mov_b64 exec, -1
    s_add_u32 s54, s54, 1
    s_cmp_eq_u32 s54, 7
    s_cselect_b32 s54, 0, s54
    s_add_u32 s60, s60, 1
    s_and_b32 s60, s60, 3
    s_lshl_b32 s55, s54, 7
    s_add_u32 s55, s55, s61
    s_mul_i32 s56, s54, 172032
    s_add_u32 s56, s56, s25
    s_lshl_b32 s57, s60, 14
    s_add_u32 s57, s57, s26
    s_mul_i32 s58, s60, 14336
    s_add_u32 s58, s58, s27
    s_waitcnt vmcnt(8)
    s_barrier
    s_add_u32 m0, s57, 0
    s_add_u32 s49, s55, 0
    buffer_load_dwordx4 v12, s[4:7], s49 offen lds
    s_add_u32 m0, s57, 1024
    s_add_u32 s49, s55, 7168
    buffer_load_dwordx4 v13, s[4:7], s49 offen lds
    s_add_u32 m0, s57, 2048
    s_add_u32 s49, s55, 14336
    buffer_load_dwordx4 v12, s[4:7], s49 offen lds
    s_add_u32 m0, s57, 3072
    s_add_u32 s49, s55, 21504
    buffer_load_dwordx4 v13, s[4:7], s49 offen lds
    s_mov_b64 exec, s[28:29]
    s_add_u32 m0, s58, 0
    s_add_u32 s49, s56, 896
    buffer_load_dwordx4 v14, s[8:11], s49 offen lds
    s_add_u32 m0, s58, 896
    s_add_u32 s49, s56, 6272
    buffer_load_dwordx4 v14, s[8:11], s49 offen lds
    s_add_u32 m0, s58, 7168
    s_add_u32 s49, s56, 1792
    buffer_load_dwordx4 v14, s[8:11], s49 offen lds
    s_add_u32 m0, s58, 8064
    s_add_u32 s49, s56, 7168
    buffer_load_dwordx4 v14, s[8:11], s49 offen lds
    s_mov_b64 exec, -1
    s_add_u32 s54, s54, 1
    s_cmp_eq_u32 s54, 7
    s_cselect_b32 s54, 0, s54
    s_add_u32 s60, s60, 1
    s_and_b32 s60, s60, 3
    s_lshl_b32 s55, s54, 7
    s_add_u32 s55, s55, s61
    s_mul_i32 s56, s54, 172032
    s_add_u32 s56, s56, s25
    s_lshl_b32 s57, s60, 14
    s_add_u32 s57, s57, s26
    s_mul_i32 s58, s60, 14336
    s_add_u32 s58, s58, s27
    s_waitcnt vmcnt(8)
    s_barrier
    s_add_u32 m0, s57, 0
    s_add_u32 s49, s55, 0
    buffer_load_dwordx4 v12, s[4:7], s49 offen lds
    s_add_u32 m0, s57, 1024
    s_add_u32 s49, s55, 7168
    buffer_load_dwordx4 v13, s[4:7], s49 offen lds
    s_add_u32 m0, s57, 2048
    s_add_u32 s49, s55, 14336
    buffer_load_dwordx4 v12, s[4:7], s49 offen lds
    s_add_u32 m0, s57, 3072
    s_add_u32 s49, s55, 21504
    buffer_load_dwordx4 v13, s[4:7], s49 offen lds
    s_mov_b64 exec, s[28:29]
    s_add_u32 m0, s58, 0
    s_add_u32 s49, s56, 896
    buffer_load_dwordx4 v14, s[8:11], s49 offen lds
    s_add_u32 m0, s58, 896
    s_add_u32 s49, s56, 6272
    buffer_load_dwordx4 v14, s[8:11], s49 offen lds
    s_add_u32 m0, s58, 7168
    s_add_u32 s49, s56, 1792
    buffer_load_dwordx4 v14, s[8:11], s49 offen lds
    s_add_u32 m0, s58, 8064
    s_add_u32 s49, s56, 7168
    buffer_load_dwordx4 v14, s[8:11], s49 offen lds
    s_mov_b64 exec, -1
    s_add_u32 s54, s54, 1
    s_cmp_eq_u32 s54, 7
    s_cselect_b32 s54, 0, s54
    s_add_u32 s60, s60, 1
    s_and_b32 s60, s60, 3
    s_lshl_b32 s55, s54, 7
    s_add_u32 s55, s55, s61
    s_mul_i32 s56, s54, 172032
    s_add_u32 s56, s56, s25
    s_lshl_b32 s57, s60, 14
    s_add_u32 s57, s57, s26
    s_mul_i32 s58, s60, 14336
    s_add_u32 s58, s58, s27
    s_waitcnt vmcnt(8)
    s_barrier
    s_add_u32 m0, s57, 0
    s_add_u32 s49, s55, 0
    buffer_load_dwordx4 v12, s[4:7], s49 offen lds
    s_add_u32 m0, s57, 1024
    s_add_u32 s49, s55, 7168
    buffer_load_dwordx4 v13, s[4:7], s49 offen lds
    s_add_u32 m0, s57, 2048
    s_add_u32 s49, s55, 14336
    buffer_load_dwordx4 v12, s[4:7], s49 offen lds
    s_add_u32 m0, s57, 3072
    s_add_u32 s49, s55, 21504
    buffer_load_dwordx4 v13, s[4:7], s49 offen lds
    s_mov_b64 exec, s[28:29]
    s_add_u32 m0, s58, 0
    s_add_u32 s49, s56, 896
    buffer_load_dwordx4 v14, s[8:11], s49 offen lds
    s_add_u32 m0, s58, 896
    s_add_u32 s49, s56, 6272
    buffer_load_dwordx4 v14, s[8:11], s49 offen lds
    s_add_u32 m0, s58, 7168
    s_add_u32 s49, s56, 1792
    buffer_load_dwordx4 v14, s[8:11], s49 offen lds
    s_add_u32 m0, s58, 8064
    s_add_u32 s49, s56, 7168
    buffer_load_dwordx4 v14, s[8:11], s49 offen lds
    s_mov_b64 exec, -1
    s_add_u32 s54, s54, 1
    s_cmp_eq_u32 s54, 7
    s_cselect_b32 s54, 0, s54
    s_add_u32 s60, s60, 1
    s_and_b32 s60, s60, 3
    s_lshl_b32 s55, s54, 7
    s_add_u32 s55, s55, s61
    s_mul_i32 s56, s54, 172032
    s_add_u32 s56, s56, s25
    s_lshl_b32 s57, s60, 14
    s_add_u32 s57, s57, s26
    s_mul_i32 s58, s60, 14336
    s_add_u32 s58, s58, s27
    s_load_dword s53, s[80:81], 0
    s_waitcnt vmcnt(8)
    s_barrier
    s_mov_b32 m0, 99328
    s_nop 0
    buffer_load_dwordx4 v2, s[16:19], 0 offen lds
    s_mov_b64 exec, s[28:29]
    s_mul_i32 s48, s34, 172032
    s_add_u32 s48, s48, s25
    s_add_u32 m0, s35, 0
    s_add_u32 s49, s48, 0
    buffer_load_dwordx4 v14, s[8:11], s49 offen lds
    s_add_u32 m0, s35, 896
    s_add_u32 s49, s48, 5376
    buffer_load_dwordx4 v14, s[8:11], s49 offen lds
    s_add_u32 s34, s34, 1
    s_cmp_eq_u32 s34, 7
    s_cselect_b32 s34, 0, s34
    s_mul_i32 s48, s34, 172032
    s_add_u32 s48, s48, s25
    s_add_u32 m0, s35, 7168
    s_add_u32 s49, s48, 0
    buffer_load_dwordx4 v14, s[8:11], s49 offen lds
    s_add_u32 m0, s35, 8064
    s_add_u32 s49, s48, 5376
    buffer_load_dwordx4 v14, s[8:11], s49 offen lds
    s_add_u32 s34, s34, 1
    s_cmp_eq_u32 s34, 7
    s_cselect_b32 s34, 0, s34
    s_mul_i32 s48, s34, 172032
    s_add_u32 s48, s48, s25
    s_add_u32 m0, s35, 14336
    s_add_u32 s49, s48, 0
    buffer_load_dwordx4 v14, s[8:11], s49 offen lds
    s_add_u32 m0, s35, 15232
    s_add_u32 s49, s48, 5376
    buffer_load_dwordx4 v14, s[8:11], s49 offen lds
    s_add_u32 s34, s34, 1
    s_cmp_eq_u32 s34, 7
    s_cselect_b32 s34, 0, s34
    s_mov_b64 exec, -1
    s_waitcnt vmcnt(7)
    s_barrier
    s_mov_b64 exec, s[28:29]
    s_mul_i32 s48, s34, 172032
    s_add_u32 s48, s48, s25
    s_add_u32 m0, s35, 21504
    s_add_u32 s49, s48, 0
    buffer_load_dwordx4 v14, s[8:11], s49 offen lds
    s_add_u32 m0, s35, 22400
    s_add_u32 s49, s48, 5376
    buffer_load_dwordx4 v14, s[8:11], s49 offen lds
    s_add_u32 s34, s34, 1
    s_cmp_eq_u32 s34, 7
    s_cselect_b32 s34, 0, s34
    s_mul_i32 s48, s34, 172032
    s_add_u32 s48, s48, s25
    s_add_u32 m0, s35, 28672
    s_add_u32 s49, s48, 0
    buffer_load_dwordx4 v14, s[8:11], s49 offen lds
    s_add_u32 m0, s35, 29568
    s_add_u32 s49, s48, 5376
    buffer_load_dwordx4 v14, s[8:11], s49 offen lds
    s_add_u32 s34, s34, 1
    s_cmp_eq_u32 s34, 7
    s_cselect_b32 s34, 0, s34
    s_mul_i32 s48, s34, 172032
    s_add_u32 s48, s48, s25
    s_add_u32 m0, s35, 84992
    s_add_u32 s49, s48, 0
    buffer_load_dwordx4 v14, s[8:11], s49 offen lds
    s_add_u32 m0, s35, 85888
    s_add_u32 s49, s48, 5376
    buffer_load_dwordx4 v14, s[8:11], s49 offen lds
    s_add_u32 s34, s34, 1
    s_cmp_eq_u32 s34, 7
    s_cselect_b32 s34, 0, s34
    s_mov_b64 exec, -1
    s_barrier
    v_mov_b32 v3, 61440
    v_mov_b32 v4, 0
    ds_write_b32 v3, v4
    v_mov_b32 v3, 61444
    v_mov_b32 v4, 0
    ds_write_b32 v3, v4
    v_mov_b32 v3, 61448
    v_mov_b32 v4, 0
    ds_write_b32 v3, v4
    v_mov_b32 v3, 61452
    v_mov_b32 v4, 0
    ds_write_b32 v3, v4
    v_mov_b32 v3, 61456
    v_mov_b32 v4, 0
    ds_write_b32 v3, v4
    s_waitcnt lgkmcnt(0)
    s_barrier
    s_mov_b64 exec, s[28:29]
    s_mul_i32 s48, s34, 172032
    s_add_u32 s48, s48, s25
    s_add_u32 m0, s35, 92160
    s_add_u32 s49, s48, 0
    buffer_load_dwordx4 v14, s[8:11], s49 offen lds
    s_add_u32 m0, s35, 93056
    s_add_u32 s49, s48, 5376
    buffer_load_dwordx4 v14, s[8:11], s49 offen lds
    s_add_u32 s34, s34, 1
    s_cmp_eq_u32 s34, 7
    s_cselect_b32 s34, 0, s34
    s_mov_b64 exec, -1
    s_waitcnt vmcnt(0)
    s_barrier
    s_bfe_u32 s46, s2, 0x10007
    s_cmp_eq_u32 s46, 0
    s_cselect_b32 s47, s68, s74
    s_cselect_b32 s48, s69, s75
    s_mov_b32 s16, s47
    s_and_b32 s17, s48, 0xffff
    s_mov_b32 s18, 401408
    s_mov_b32 s19, 0x20000
    s_bfe_u32 s46, s2, 0x40003
    s_mul_i32 s46, s46, 196
    s_mul_i32 s47, s20, 49
    s_add_u32 s46, s46, s47
    s_lshl_b32 s46, s46, 7
    v_lshlrev_b32 v3, 7, v1
    v_add_u32 v3, s46, v3
    v_cmp_gt_u32 vcc, 49, v1
    v_mov_b32 v4, 0x80000000
    s_nop 0
    v_cndmask_b32 v3, v4, v3, vcc
    buffer_load_dword v9, v3, s[16:19], 0 offen
    s_cmp_eq_u32 s21, 0
    s_cbranch_scc1 L_loader_lin
    s_lshl_b32 s59, s23, 1
    s_mul_i32 s48, s20, 2
    s_lshl_b32 s57, s48, 12
    s_add_u32 s57, s57, 114688
    s_lshl_b32 s46, s22, 2
    s_add_u32 s46, s46, s48
    s_sub_i32 s54, s46, 8
    s_lshl_b32 s47, s59, 6
    s_add_i32 s47, s47, s54
    s_lshl_b32 s55, s47, 11
    s_add_u32 s47, s55, 0
    s_cmp_lt_i32 s54, 0
    s_cselect_b32 s30, 0x40000000, s47
    s_add_u32 s47, s55, 2048
    s_cmp_lt_i32 s54, -1
    s_cselect_b32 s31, 0x40000000, s47
    s_cmp_lg_u32 s20, 0
    s_cbranch_scc1 L_wf_o_1
    s_cmp_lg_u32 s53, 0
    s_cbranch_scc1 L_nok_3
    s_mov_b32 s63, 262144
    v_mov_b32 v4, 0
L_npoll_4:
    buffer_load_dword v3, v4, s[96:99], 0 offen sc1
    s_waitcnt vmcnt(0)
    v_readfirstlane_b32 s53, v3
    s_sub_u32 s63, s63, 1
    s_cbranch_scc1 L_nok_3
    s_cmp_eq_u32 s53, 0
    s_cbranch_scc1 L_npoll_4
L_nok_3:
    v_sub_u32 v5, s22, v1
    v_lshlrev_b32 v5, 3, v5
    v_add_u32 v5, s23, v5
    v_lshlrev_b32 v5, 7, v5
    v_add_u32 v5, 10616832, v5
    s_min_u32 s46, s22, 2
    s_add_u32 s46, s46, 1
    s_bfm_b32 s84, s46, 0
    s_andn2_b32 s84, s84, 1
    s_mov_b32 s85, 0
    s_cmp_eq_u64 s[84:85], 0
    s_cbranch_scc1 L_polled_6
    s_mov_b32 s63, 262144
    s_mov_b64 exec, s[84:85]
L_poll_5:
    buffer_load_dword v6, v5, s[12:15], 0 offen sc1
    s_waitcnt vmcnt(0)
    v_cmp_ne_u32 vcc, s53, v6
    s_sub_u32 s63, s63, 1
    s_cbranch_scc1 L_polled_6
    s_cmp_lg_u64 vcc, 0
    s_cbranch_scc1 L_poll_5
L_polled_6:
    s_mov_b64 exec, -1
    v_mov_b32 v3, 61440
    v_mov_b32 v4, 1
    ds_write_b32 v3, v4
    s_branch L_wf_go_2
L_wf_o_1:
    s_mov_b32 s63, 2097152
    v_mov_b32 v3, 61440
L_lspin_7:
    ds_read_b32 v4, v3
    s_waitcnt lgkmcnt(0)
    v_readfirstlane_b32 s46, v4
    s_sub_u32 s63, s63, 1
    s_cbranch_scc1 L_lspun_8
    s_cmp_eq_u32 s46, 0
    s_cbranch_scc1 L_lspin_7
L_lspun_8:
L_wf_go_2:
    s_add_u32 m0, s57, 0
    s_add_u32 s47, s30, 2101248
    buffer_load_dwordx4 v2, s[12:15], s47 offen lds
    s_add_u32 m0, s57, 1024
    s_add_u32 s47, s30, 2102272
    buffer_load_dwordx4 v2, s[12:15], s47 offen lds
    s_add_u32 m0, s57, 4096
    s_add_u32 s47, s31, 2101248
    buffer_load_dwordx4 v2, s[12:15], s47 offen lds
    s_add_u32 m0, s57, 5120
    s_add_u32 s47, s31, 2102272
    buffer_load_dwordx4 v2, s[12:15], s47 offen lds
    s_add_u32 m0, s57, 2048
    s_add_u32 s47, s30, 4202496
    buffer_load_dwordx4 v2, s[12:15], s47 offen lds
    s_add_u32 m0, s57, 3072
    s_add_u32 s47, s30, 4203520
    buffer_load_dwordx4 v2, s[12:15], s47 offen lds
    s_add_u32 m0, s57, 6144
    s_add_u32 s47, s31, 4202496
    buffer_load_dwordx4 v2, s[12:15], s47 offen lds
    s_add_u32 m0, s57, 7168
    s_add_u32 s47, s31, 4203520
    buffer_load_dwordx4 v2, s[12:15], s47 offen lds
    s_waitcnt vmcnt(4)
L_kw_9:
    s_cmp_ge_i32 s54, 0
    s_cbranch_scc1 L_kvok_10
    v_add_u32 v3, s57, v2
    v_mov_b32 v4, 0xf149
    s_mov_b32 exec_lo, 0
    s_cmp_ge_i32 s54, 0
    s_cbranch_scc1 L_kvmark_L_kvok_10
    ds_write_b32 v3, v4 offset:1032
    s_cmp_ge_i32 s54, -1
    s_cbranch_scc1 L_kvmark_L_kvok_10
    ds_write_b32 v3, v4 offset:5128
L_kvmark_L_kvok_10:
    s_mov_b32 exec_lo, -1
    s_waitcnt lgkmcnt(0)
L_kvok_10:
    s_barrier
    s_waitcnt vmcnt(0)
    s_barrier
    v_lshrrev_b32 v3, 3, v1
    v_mul_u32_u24 v3, 896, v3
    v_bfe_u32 v4, v1, 4, 1
    v_lshlrev_b32 v4, 2, v4
    v_and_b32 v5, 7, v1
    v_xor_b32 v5, v5, v4
    v_lshl_add_u32 v15, v5, 4, v3
    s_cmp_lt_u32 s20, 2
    s_cselect_b32 s47, s68, s74
    s_cselect_b32 s48, s69, s75
    s_mov_b32 s16, s47
    s_and_b32 s17, s48, 0xffff
    s_mov_b32 s18, 401408
    s_mov_b32 s19, 0x20000
    s_mul_i32 s58, s20, 28672
    s_and_b32 s46, s20, 1
    s_mul_i32 s56, s46, 200704
    s_lshl_b32 s46, s52, 7
    s_add_u32 s56, s56, s46
    s_cmp_eq_u32 s52, 7
    s_cbranch_scc1 L_fin
    s_add_u32 m0, s58, 0
    s_add_u32 s49, s56, 0
    buffer_load_dwordx4 v15, s[16:19], s49 offen lds
    s_add_u32 m0, s58, 1024
    s_add_u32 s49, s56, 7168
    buffer_load_dwordx4 v15, s[16:19], s49 offen lds
    s_add_u32 m0, s58, 2048
    s_add_u32 s49, s56, 14336
    buffer_load_dwordx4 v15, s[16:19], s49 offen lds
    s_add_u32 m0, s58, 3072
    s_add_u32 s49, s56, 21504
    buffer_load_dwordx4 v15, s[16:19], s49 offen lds
    s_add_u32 m0, s58, 4096
    s_add_u32 s49, s56, 28672
    buffer_load_dwordx4 v15, s[16:19], s49 offen lds
    s_add_u32 m0, s58, 5120
    s_add_u32 s49, s56, 35840
    buffer_load_dwordx4 v15, s[16:19], s49 offen lds
    s_add_u32 m0, s58, 6144
    s_add_u32 s49, s56, 43008
    buffer_load_dwordx4 v15, s[16:19], s49 offen lds
    s_add_u32 m0, s58, 7168
    s_add_u32 s49, s56, 50176
    buffer_load_dwordx4 v15, s[16:19], s49 offen lds
    s_add_u32 m0, s58, 8192
    s_add_u32 s49, s56, 57344
    buffer_load_dwordx4 v15, s[16:19], s49 offen lds
    s_add_u32 m0, s58, 9216
    s_add_u32 s49, s56, 64512
    buffer_load_dwordx4 v15, s[16:19], s49 offen lds
    s_add_u32 m0, s58, 10240
    s_add_u32 s49, s56, 71680
    buffer_load_dwordx4 v15, s[16:19], s49 offen lds
    s_add_u32 m0, s58, 11264
    s_add_u32 s49, s56, 78848
    buffer_load_dwordx4 v15, s[16:19], s49 offen lds
    s_add_u32 m0, s58, 12288
    s_add_u32 s49, s56, 86016
    buffer_load_dwordx4 v15, s[16:19], s49 offen lds
    s_add_u32 m0, s58, 13312
    s_add_u32 s49, s56, 93184
    buffer_load_dwordx4 v15, s[16:19], s49 offen lds
    s_add_u32 m0, s58, 14336
    s_add_u32 s49, s56, 100352
    buffer_load_dwordx4 v15, s[16:19], s49 offen lds
    s_add_u32 m0, s58, 15360
    s_add_u32 s49, s56, 107520
    buffer_load_dwordx4 v15, s[16:19], s49 offen lds
    s_add_u32 m0, s58, 16384
    s_add_u32 s49, s56, 114688
    buffer_load_dwordx4 v15, s[16:19], s49 offen lds
    s_add_u32 m0, s58, 17408
    s_add_u32 s49, s56, 121856
    buffer_load_dwordx4 v15, s[16:19], s49 offen lds
    s_add_u32 m0, s58, 18432
    s_add_u32 s49, s56, 129024
    buffer_load_dwordx4 v15, s[16:19], s49 offen lds
    s_add_u32 m0, s58, 19456
    s_add_u32 s49, s56, 136192
    buffer_load_dwordx4 v15, s[16:19], s49 offen lds
    s_add_u32 m0, s58, 20480
    s_add_u32 s49, s56, 143360
    buffer_load_dwordx4 v15, s[16:19], s49 offen lds
    s_add_u32 m0, s58, 21504
    s_add_u32 s49, s56, 150528
    buffer_load_dwordx4 v15, s[16:19], s49 offen lds
    s_add_u32 m0, s58, 22528
    s_add_u32 s49, s56, 157696
    buffer_load_dwordx4 v15, s[16:19], s49 offen lds
    s_add_u32 m0, s58, 23552
    s_add_u32 s49, s56, 164864
    buffer_load_dwordx4 v15, s[16:19], s49 offen lds
    s_add_u32 m0, s58, 24576
    s_add_u32 s49, s56, 172032
    buffer_load_dwordx4 v15, s[16:19], s49 offen lds
    s_add_u32 m0, s58, 25600
    s_add_u32 s49, s56, 179200
    buffer_load_dwordx4 v15, s[16:19], s49 offen lds
    s_add_u32 m0, s58, 26624
    s_add_u32 s49, s56, 186368
    buffer_load_dwordx4 v15, s[16:19], s49 offen lds
    s_add_u32 m0, s58, 27648
    s_add_u32 s49, s56, 193536
    buffer_load_dwordx4 v15, s[16:19], s49 offen lds
    s_lshr_b32 s86, s24, 2
    s_lshl_b32 s46, s51, 1
    s_add_u32 s46, s46, s86
    s_lshl_b32 s89, s46, 7
    s_add_u32 s89, s89, 10571776
    s_mul_i32 s88, s46, 28672
    s_lshl_b32 s47, s52, 7
    s_add_u32 s88, s88, s47
    s_lshl_b32 s47, s20, 5
    s_add_u32 s88, s88, s47
    s_lshl_b32 s46, s46, 5
    s_lshl_b32 s47, s20, 3
    s_add_u32 s46, s46, s47
    s_lshl_b32 s46, s46, 11
    s_add_u32 s87, s46, 6307840
    s_mov_b32 s8, s40
    s_and_b32 s9, s41, 0xffff
    s_mov_b32 s10, 1835008
    s_mov_b32 s11, 0x20000
    v_bfe_u32 v142, v1, 2, 2
    v_lshrrev_b32 v147, 5, v1
    v_lshl_add_u32 v143, v147, 2, v142
    v_lshlrev_b32 v143, 7, v143
    s_mul_i32 s47, s20, 28672
    v_add_u32 v143, s47, v143
    v_and_b32 v144, 1, v1
    v_lshl_add_u32 v143, v144, 3, v143
    v_bfe_u32 v144, v1, 4, 1
    v_lshlrev_b32 v144, 1, v144
    v_bfe_u32 v145, v1, 1, 1
    v_or_b32 v144, v144, v145
    v_lshrrev_b32 v145, 1, v142
    v_lshlrev_b32 v145, 2, v145
    v_or_b32 v146, v144, v145
    v_lshl_add_u32 v128, v146, 4, v143
    v_xor_b32 v145, 4, v145
    v_or_b32 v146, v144, v145
    v_lshl_add_u32 v129, v146, 4, v143
    v_lshlrev_b32 v147, 9, v147
    v_sub_u32 v130, v128, v147
    v_sub_u32 v131, v129, v147
    s_mul_i32 s46, s86, 24576
    s_add_u32 s46, s46, 114688
    v_add_u32 v132, s46, v2
    s_mul_i32 s47, s20, 6144
    v_add_u32 v133, s47, v132
    v_and_b32 v142, 31, v1
    v_lshlrev_b32 v136, 2, v142
    v_mul_u32_u24 v134, 896, v142
    v_lshrrev_b32 v143, 5, v1
    v_lshl_add_u32 v134, v143, 4, v134
    s_cmp_lg_u32 s20, 0
    s_cbranch_scc1 L_noow_11
    s_lshl_b32 s46, s22, 4
    v_add_u32 v5, s46, v1
    v_lshlrev_b32 v5, 7, v5
    v_add_u32 v5, 10649600, v5
    s_mov_b32 s84, 0xffff
    s_mov_b32 s85, 0
    s_cmp_eq_u64 s[84:85], 0
    s_cbranch_scc1 L_polled_13
    s_mov_b32 s63, 262144
    s_mov_b64 exec, s[84:85]
L_poll_12:
    buffer_load_dword v6, v5, s[12:15], 0 offen sc1
    s_waitcnt vmcnt(0)
    v_cmp_ne_u32 vcc, s53, v6
    s_sub_u32 s63, s63, 1
    s_cbranch_scc1 L_polled_13
    s_cmp_lg_u64 vcc, 0
    s_cbranch_scc1 L_poll_12
L_polled_13:
    s_mov_b64 exec, -1
L_noow_11:
    s_waitcnt vmcnt(0)
    s_barrier
    s_branch L_final
L_loader_lin:
    s_lshl_b32 s59, s23, 1
    s_add_u32 s59, s59, 1
    s_mul_i32 s48, s20, 3
    s_lshl_b32 s57, s48, 12
    s_add_u32 s57, s57, 114688
    s_lshl_b32 s46, s22, 2
    s_add_u32 s46, s46, s48
    s_sub_i32 s54, s46, 8
    s_lshl_b32 s47, s59, 6
    s_add_i32 s47, s47, s54
    s_lshl_b32 s55, s47, 11
    s_add_u32 s47, s55, 0
    s_cmp_lt_i32 s54, 0
    s_cselect_b32 s30, 0x40000000, s47
    s_add_u32 s47, s55, 2048
    s_cmp_lt_i32 s54, -1
    s_cselect_b32 s31, 0x40000000, s47
    s_add_u32 s47, s55, 4096
    s_cmp_lt_i32 s54, -2
    s_cselect_b32 s32, 0x40000000, s47
    s_lshl_b32 s48, s23, 7
    s_lshl_b32 s47, s22, 2
    s_add_u32 s48, s48, s47
    s_add_u32 s48, s48, s20
    s_lshl_b32 s48, s48, 11
    s_add_u32 s33, s48, 131072
    s_lshl_b32 s56, s20, 11
    s_cmp_lg_u32 s20, 0
    s_cbranch_scc1 L_wf_o_14
    s_cmp_lg_u32 s53, 0
    s_cbranch_scc1 L_nok_16
    s_mov_b32 s63, 262144
    v_mov_b32 v4, 0
L_npoll_17:
    buffer_load_dword v3, v4, s[96:99], 0 offen sc1
    s_waitcnt vmcnt(0)
    v_readfirstlane_b32 s53, v3
    s_sub_u32 s63, s63, 1
    s_cbranch_scc1 L_nok_16
    s_cmp_eq_u32 s53, 0
    s_cbranch_scc1 L_npoll_17
L_nok_16:
    v_sub_u32 v5, s22, v1
    v_lshlrev_b32 v5, 3, v5
    v_add_u32 v5, s23, v5
    v_lshlrev_b32 v5, 7, v5
    v_add_u32 v5, 10616832, v5
    s_min_u32 s46, s22, 2
    s_add_u32 s46, s46, 1
    s_bfm_b32 s84, s46, 0
    s_mov_b32 s85, 0
    s_cmp_eq_u64 s[84:85], 0
    s_cbranch_scc1 L_polled_19
    s_mov_b32 s63, 262144
    s_mov_b64 exec, s[84:85]
L_poll_18:
    buffer_load_dword v6, v5, s[12:15], 0 offen sc1
    s_waitcnt vmcnt(0)
    v_cmp_ne_u32 vcc, s53, v6
    s_sub_u32 s63, s63, 1
    s_cbranch_scc1 L_polled_19
    s_cmp_lg_u64 vcc, 0
    s_cbranch_scc1 L_poll_18
L_polled_19:
    s_mov_b64 exec, -1
    v_mov_b32 v3, 61440
    v_mov_b32 v4, 1
    ds_write_b32 v3, v4
    s_branch L_wf_go_15
L_wf_o_14:
    s_mov_b32 s63, 2097152
    v_mov_b32 v3, 61440
L_lspin_20:
    ds_read_b32 v4, v3
    s_waitcnt lgkmcnt(0)
    v_readfirstlane_b32 s46, v4
    s_sub_u32 s63, s63, 1
    s_cbranch_scc1 L_lspun_21
    s_cmp_eq_u32 s46, 0
    s_cbranch_scc1 L_lspin_20
L_lspun_21:
L_wf_go_15:
    s_mov_b32 s63, 2097152
    v_mov_b32 v3, 61452
L_cspin_22:
    ds_read_b32 v4, v3
    s_waitcnt lgkmcnt(0)
    v_readfirstlane_b32 s46, v4
    s_sub_u32 s63, s63, 1
    s_cbranch_scc1 L_cspun_23
    s_cmp_lt_u32 s46, 4
    s_cbranch_scc1 L_cspin_22
L_cspun_23:
    s_add_u32 m0, s56, 36864
    s_add_u32 s47, s33, 0
    buffer_load_dwordx4 v2, s[12:15], s47 offen lds
    s_add_u32 m0, s56, 37888
    s_add_u32 s47, s33, 1024
    buffer_load_dwordx4 v2, s[12:15], s47 offen lds
    s_add_u32 m0, s57, 0
    s_add_u32 s47, s30, 2101248
    buffer_load_dwordx4 v2, s[12:15], s47 offen lds
    s_add_u32 m0, s57, 1024
    s_add_u32 s47, s30, 2102272
    buffer_load_dwordx4 v2, s[12:15], s47 offen lds
    s_add_u32 m0, s57, 4096
    s_add_u32 s47, s31, 2101248
    buffer_load_dwordx4 v2, s[12:15], s47 offen lds
    s_add_u32 m0, s57, 5120
    s_add_u32 s47, s31, 2102272
    buffer_load_dwordx4 v2, s[12:15], s47 offen lds
    s_add_u32 m0, s57, 8192
    s_add_u32 s47, s32, 2101248
    buffer_load_dwordx4 v2, s[12:15], s47 offen lds
    s_add_u32 m0, s57, 9216
    s_add_u32 s47, s32, 2102272
    buffer_load_dwordx4 v2, s[12:15], s47 offen lds
    s_add_u32 m0, s57, 2048
    s_add_u32 s47, s30, 4202496
    buffer_load_dwordx4 v2, s[12:15], s47 offen lds
    s_add_u32 m0, s57, 3072
    s_add_u32 s47, s30, 4203520
    buffer_load_dwordx4 v2, s[12:15], s47 offen lds
    s_add_u32 m0, s57, 6144
    s_add_u32 s47, s31, 4202496
    buffer_load_dwordx4 v2, s[12:15], s47 offen lds
    s_add_u32 m0, s57, 7168
    s_add_u32 s47, s31, 4203520
    buffer_load_dwordx4 v2, s[12:15], s47 offen lds
    s_add_u32 m0, s57, 10240
    s_add_u32 s47, s32, 4202496
    buffer_load_dwordx4 v2, s[12:15], s47 offen lds
    s_add_u32 m0, s57, 11264
    s_add_u32 s47, s32, 4203520
    buffer_load_dwordx4 v2, s[12:15], s47 offen lds
    v_and_b32 v5, 15, v1
    v_lshlrev_b32 v5, 3, v5
    v_add_u32 v5, s23, v5
    v_lshlrev_b32 v5, 7, v5
    v_add_u32 v5, 10633216, v5
    s_cmp_lg_u32 s20, 0
    s_cbranch_scc1 L_p1_24
    buffer_load_dword v8, v5, s[12:15], 0 offen sc1
    s_waitcnt vmcnt(7)
L_p1_24:
    s_cmp_eq_u32 s20, 0
    s_cbranch_scc1 L_kw_25
    s_waitcnt vmcnt(6)
L_kw_25:
    s_cmp_ge_i32 s54, 0
    s_cbranch_scc1 L_kvok_26
    v_add_u32 v3, s57, v2
    v_mov_b32 v4, 0xf149
    s_mov_b32 exec_lo, 0
    s_cmp_ge_i32 s54, 0
    s_cbranch_scc1 L_kvmark_L_kvok_26
    ds_write_b32 v3, v4 offset:1032
    s_cmp_ge_i32 s54, -1
    s_cbranch_scc1 L_kvmark_L_kvok_26
    ds_write_b32 v3, v4 offset:5128
    s_cmp_ge_i32 s54, -2
    s_cbranch_scc1 L_kvmark_L_kvok_26
    ds_write_b32 v3, v4 offset:9224
L_kvmark_L_kvok_26:
    s_mov_b32 exec_lo, -1
    s_waitcnt lgkmcnt(0)
L_kvok_26:
    s_barrier
    s_waitcnt vmcnt(0)
    s_cmp_lg_u32 s20, 0
    s_cbranch_scc1 L_wf_z0_27
    v_cmp_ne_u32 vcc, s53, v8
    s_nop 0
    s_cmp_eq_u64 vcc, 0
    s_cselect_b32 s36, 1, 0
    v_mov_b32 v3, 118768
    v_mov_b32 v4, s36
    ds_write_b32 v3, v4
    s_waitcnt lgkmcnt(0)
L_wf_z0_27:
    s_cmp_lg_u32 s20, 3
    s_cbranch_scc1 L_wf_z3_28
    v_mov_b32 v3, 163808
    v_mov_b32 v4, 0
    ds_write_b32 v3, v4
    s_waitcnt lgkmcnt(0)
L_wf_z3_28:
    s_barrier
    s_mul_i32 s46, s20, 28672
    v_add_u32 v3, s46, v2
    ds_read_b128 v[16:19], v3 offset:0
    ds_read_b128 v[20:23], v3 offset:1024
    ds_read_b128 v[24:27], v3 offset:2048
    ds_read_b128 v[28:31], v3 offset:3072
    s_cmp_lg_u32 s20, 0
    s_cbranch_scc1 L_pw_o_29
    s_cmp_lg_u32 s36, 0
    s_cbranch_scc1 L_pw_go_30
    s_mov_b32 s84, 0xffff
    s_mov_b32 s85, 0
    s_cmp_eq_u64 s[84:85], 0
    s_cbranch_scc1 L_polled_32
    s_mov_b32 s63, 262144
    s_mov_b64 exec, s[84:85]
L_poll_31:
    buffer_load_dword v6, v5, s[12:15], 0 offen sc1
    s_waitcnt vmcnt(0)
    v_cmp_ne_u32 vcc, s53, v6
    s_sub_u32 s63, s63, 1
    s_cbranch_scc1 L_polled_32
    s_cmp_lg_u64 vcc, 0
    s_cbranch_scc1 L_poll_31
L_polled_32:
    s_mov_b64 exec, -1
    v_mov_b32 v3, 118768
    v_mov_b32 v4, 1
    ds_write_b32 v3, v4
    s_branch L_pw_go_30
L_pw_o_29:
    s_mov_b32 s63, 2097152
    v_mov_b32 v3, 118768
L_lspin_33:
    ds_read_b32 v4, v3
    s_waitcnt lgkmcnt(0)
    v_readfirstlane_b32 s46, v4
    s_sub_u32 s63, s63, 1
    s_cbranch_scc1 L_lspun_34
    s_cmp_eq_u32 s46, 0
    s_cbranch_scc1 L_lspin_33
L_lspun_34:
L_pw_go_30:
    v_lshrrev_b32 v3, 3, v1
    v_mul_u32_u24 v3, 896, v3
    v_bfe_u32 v4, v1, 4, 1
    v_lshlrev_b32 v4, 2, v4
    v_and_b32 v5, 7, v1
    v_xor_b32 v5, v5, v4
    v_lshl_add_u32 v15, v5, 4, v3
    s_cmp_lt_u32 s20, 2
    s_cselect_b32 s47, s68, s74
    s_cselect_b32 s48, s69, s75
    s_mov_b32 s16, s47
    s_and_b32 s17, s48, 0xffff
    s_mov_b32 s18, 401408
    s_mov_b32 s19, 0x20000
    s_mul_i32 s58, s20, 28672
    s_and_b32 s46, s20, 1
    s_mul_i32 s56, s46, 200704
    s_lshl_b32 s46, s52, 7
    s_add_u32 s56, s56, s46
    s_mov_b32 s44, 0
    s_mov_b32 s45, -1
    s_lshl_b32 s46, s23, 13
    s_add_u32 s46, s46, 10506240
    s_add_u32 m0, s58, 4096
    s_add_u32 s47, s46, 0
    buffer_load_dwordx4 v2, s[12:15], s47 offen lds
    s_add_u32 m0, s58, 5120
    s_add_u32 s47, s46, 1024
    buffer_load_dwordx4 v2, s[12:15], s47 offen lds
    s_add_u32 m0, s58, 6144
    s_add_u32 s47, s46, 2048
    buffer_load_dwordx4 v2, s[12:15], s47 offen lds
    s_add_u32 m0, s58, 7168
    s_add_u32 s47, s46, 3072
    buffer_load_dwordx4 v2, s[12:15], s47 offen lds
    s_add_u32 m0, s58, 8192
    s_add_u32 s47, s46, 4096
    buffer_load_dwordx4 v2, s[12:15], s47 offen lds
    s_add_u32 m0, s58, 9216
    s_add_u32 s47, s46, 5120
    buffer_load_dwordx4 v2, s[12:15], s47 offen lds
    s_add_u32 m0, s58, 10240
    s_add_u32 s47, s46, 6144
    buffer_load_dwordx4 v2, s[12:15], s47 offen lds
    s_add_u32 m0, s58, 11264
    s_add_u32 s47, s46, 7168
    buffer_load_dwordx4 v2, s[12:15], s47 offen lds
    s_add_u32 m0, s58, 12288
    s_add_u32 s49, s56, 86016
    buffer_load_dwordx4 v15, s[16:19], s49 offen lds
    s_add_u32 m0, s58, 13312
    s_add_u32 s49, s56, 93184
    buffer_load_dwordx4 v15, s[16:19], s49 offen lds
    s_add_u32 m0, s58, 14336
    s_add_u32 s49, s56, 100352
    buffer_load_dwordx4 v15, s[16:19], s49 offen lds
    s_add_u32 m0, s58, 15360
    s_add_u32 s49, s56, 107520
    buffer_load_dwordx4 v15, s[16:19], s49 offen lds
    s_add_u32 m0, s58, 16384
    s_add_u32 s49, s56, 114688
    buffer_load_dwordx4 v15, s[16:19], s49 offen lds
    s_add_u32 m0, s58, 17408
    s_add_u32 s49, s56, 121856
    buffer_load_dwordx4 v15, s[16:19], s49 offen lds
    s_add_u32 m0, s58, 18432
    s_add_u32 s49, s56, 129024
    buffer_load_dwordx4 v15, s[16:19], s49 offen lds
    s_add_u32 m0, s58, 19456
    s_add_u32 s49, s56, 136192
    buffer_load_dwordx4 v15, s[16:19], s49 offen lds
    s_add_u32 m0, s58, 20480
    s_add_u32 s49, s56, 143360
    buffer_load_dwordx4 v15, s[16:19], s49 offen lds
    s_add_u32 m0, s58, 21504
    s_add_u32 s49, s56, 150528
    buffer_load_dwordx4 v15, s[16:19], s49 offen lds
    v_lshlrev_b32 v3, 2, v1
    v_add_u32 v3, s58, v3
    s_waitcnt vmcnt(10)
    s_waitcnt lgkmcnt(0)
    ds_read2st64_b32 v[32:33], v3 offset0:16 offset1:17
    ds_read2st64_b32 v[34:35], v3 offset0:18 offset1:19
    ds_read2st64_b32 v[36:37], v3 offset0:20 offset1:21
    ds_read2st64_b32 v[38:39], v3 offset0:22 offset1:23
    ds_read2st64_b32 v[40:41], v3 offset0:24 offset1:25
    ds_read2st64_b32 v[42:43], v3 offset0:26 offset1:27
    ds_read2st64_b32 v[44:45], v3 offset0:28 offset1:29
    ds_read2st64_b32 v[46:47], v3 offset0:30 offset1:31
    ds_read2st64_b32 v[48:49], v3 offset0:32 offset1:33
    ds_read2st64_b32 v[50:51], v3 offset0:34 offset1:35
    ds_read2st64_b32 v[52:53], v3 offset0:36 offset1:37
    ds_read2st64_b32 v[54:55], v3 offset0:38 offset1:39
    ds_read2st64_b32 v[56:57], v3 offset0:40 offset1:41
    ds_read2st64_b32 v[58:59], v3 offset0:42 offset1:43
    s_waitcnt lgkmcnt(6)
    ds_read2st64_b32 v[60:61], v3 offset0:44 offset1:45
    ds_read2st64_b32 v[62:63], v3 offset0:46 offset1:47
    v_cvt_pk_bf16_f32 v32, v32, v33
    v_cvt_pk_bf16_f32 v33, v34, v35
    v_cvt_pk_bf16_f32 v34, v36, v37
    v_cvt_pk_bf16_f32 v35, v38, v39
    v_cvt_pk_bf16_f32 v36, v40, v41
    v_cvt_pk_bf16_f32 v37, v42, v43
    v_cvt_pk_bf16_f32 v38, v44, v45
    v_cvt_pk_bf16_f32 v39, v46, v47
    s_nop 1
    v_mfma_f32_32x32x16_bf16 v[64:79], v[32:35], v[16:19], 0
    v_mfma_f32_32x32x16_bf16 v[64:79], v[36:39], v[20:23], v[64:79]
    s_waitcnt lgkmcnt(0)
    v_cvt_pk_bf16_f32 v48, v48, v49
    v_cvt_pk_bf16_f32 v49, v50, v51
    v_cvt_pk_bf16_f32 v50, v52, v53
    v_cvt_pk_bf16_f32 v51, v54, v55
    v_cvt_pk_bf16_f32 v52, v56, v57
    v_cvt_pk_bf16_f32 v53, v58, v59
    v_cvt_pk_bf16_f32 v54, v60, v61
    v_cvt_pk_bf16_f32 v55, v62, v63
    s_nop 1
    v_mfma_f32_32x32x16_bf16 v[80:95], v[48:51], v[24:27], 0
    v_mfma_f32_32x32x16_bf16 v[80:95], v[52:55], v[28:31], v[80:95]
    s_nop 7
    s_nop 7
    v_mov_b32 v4, v76
    v_mov_b32 v5, v76
    s_nop 1
    v_permlane32_swap_b32 v4, v5
    s_nop 1
    v_add_f32 v5, 0x358637bd, v5
    v_rcp_f32 v4, v5
    s_nop 0
    v_pk_mul_f32 v[64:65], v[64:65], v[4:5] op_sel_hi:[1,0]
    v_pk_mul_f32 v[66:67], v[66:67], v[4:5] op_sel_hi:[1,0]
    v_pk_mul_f32 v[68:69], v[68:69], v[4:5] op_sel_hi:[1,0]
    v_pk_mul_f32 v[70:71], v[70:71], v[4:5] op_sel_hi:[1,0]
    v_pk_mul_f32 v[72:73], v[72:73], v[4:5] op_sel_hi:[1,0]
    v_pk_mul_f32 v[74:75], v[74:75], v[4:5] op_sel_hi:[1,0]
    v_pk_mul_f32 v[76:77], v[76:77], v[4:5] op_sel_hi:[1,0]
    v_pk_mul_f32 v[78:79], v[78:79], v[4:5] op_sel_hi:[1,0]
    v_cvt_pk_bf16_f32 v64, v64, v65
    v_cvt_pk_bf16_f32 v65, v66, v67
    v_cvt_pk_bf16_f32 v66, v68, v69
    v_cvt_pk_bf16_f32 v67, v70, v71
    v_cvt_pk_bf16_f32 v68, v72, v73
    v_cvt_pk_bf16_f32 v69, v74, v75
    v_cvt_pk_bf16_f32 v70, v76, v77
    v_cvt_pk_bf16_f32 v71, v78, v79
    v_cndmask_b32_e64 v70, v70, 0, s[44:45]
    v_cndmask_b32_e64 v71, v71, 0, s[44:45]
    s_lshl_b32 s48, s23, 1
    s_add_u32 s48, s48, 0
    s_lshl_b32 s46, s22, 2
    s_add_u32 s46, s46, s20
    s_lshl_b32 s46, s46, 5
    s_add_u32 s46, s46, s48
    s_lshl_b32 s46, s46, 11
    s_add_u32 s46, s46, 6307840
    buffer_store_dwordx4 v[64:67], v2, s[12:15], s46 offen offset:0 sc1
    buffer_store_dwordx4 v[68:71], v2, s[12:15], s46 offen offset:1024 sc1
    v_mov_b32 v4, v92
    v_mov_b32 v5, v92
    s_nop 1
    v_permlane32_swap_b32 v4, v5
    s_nop 1
    v_add_f32 v5, 0x358637bd, v5
    v_rcp_f32 v4, v5
    s_nop 0
    v_pk_mul_f32 v[80:81], v[80:81], v[4:5] op_sel_hi:[1,0]
    v_pk_mul_f32 v[82:83], v[82:83], v[4:5] op_sel_hi:[1,0]
    v_pk_mul_f32 v[84:85], v[84:85], v[4:5] op_sel_hi:[1,0]
    v_pk_mul_f32 v[86:87], v[86:87], v[4:5] op_sel_hi:[1,0]
    v_pk_mul_f32 v[88:89], v[88:89], v[4:5] op_sel_hi:[1,0]
    v_pk_mul_f32 v[90:91], v[90:91], v[4:5] op_sel_hi:[1,0]
    v_pk_mul_f32 v[92:93], v[92:93], v[4:5] op_sel_hi:[1,0]
    v_pk_mul_f32 v[94:95], v[94:95], v[4:5] op_sel_hi:[1,0]
    v_cvt_pk_bf16_f32 v80, v80, v81
    v_cvt_pk_bf16_f32 v81, v82, v83
    v_cvt_pk_bf16_f32 v82, v84, v85
    v_cvt_pk_bf16_f32 v83, v86, v87
    v_cvt_pk_bf16_f32 v84, v88, v89
    v_cvt_pk_bf16_f32 v85, v90, v91
    v_cvt_pk_bf16_f32 v86, v92, v93
    v_cvt_pk_bf16_f32 v87, v94, v95
    v_cndmask_b32_e64 v86, v86, 0, s[44:45]
    v_cndmask_b32_e64 v87, v87, 0, s[44:45]
    s_lshl_b32 s48, s23, 1
    s_add_u32 s48, s48, 1
    s_lshl_b32 s46, s22, 2
    s_add_u32 s46, s46, s20
    s_lshl_b32 s46, s46, 5
    s_add_u32 s46, s46, s48
    s_lshl_b32 s46, s46, 11
    s_add_u32 s46, s46, 6307840
    buffer_store_dwordx4 v[80:83], v2, s[12:15], s46 offen offset:0 sc1
    buffer_store_dwordx4 v[84:87], v2, s[12:15], s46 offen offset:1024 sc1
    s_waitcnt vmcnt(0)
    v_mov_b32 v3, 163808
    v_mov_b32 v4, 1
    s_mov_b64 exec, 1
    ds_add_rtn_u32 v4, v3, v4
    s_mov_b64 exec, -1
    s_waitcnt lgkmcnt(0)
    v_readfirstlane_b32 s46, v4
    s_cmp_lg_u32 s46, 7
    s_cbranch_scc1 L_notlast_35
    s_cmp_lg_u32 s53, 0
    s_cbranch_scc1 L_nok_36
    s_mov_b32 s63, 262144
    v_mov_b32 v4, 0
L_npoll_37:
    buffer_load_dword v3, v4, s[96:99], 0 offen sc1
    s_waitcnt vmcnt(0)
    v_readfirstlane_b32 s53, v3
    s_sub_u32 s63, s63, 1
    s_cbranch_scc1 L_nok_36
    s_cmp_eq_u32 s53, 0
    s_cbranch_scc1 L_npoll_37
L_nok_36:
    s_mul_i32 s46, s22, 16
    s_add_u32 s46, s46, s50
    s_lshl_b32 s46, s46, 7
    s_add_u32 s46, s46, 10649600
    v_mov_b32 v3, s53
    v_mov_b32 v4, 0
    s_mov_b64 exec, 1
    buffer_store_dword v3, v4, s[12:15], s46 offen sc1
    s_mov_b64 exec, -1
L_notlast_35:
    s_cmp_eq_u32 s52, 7
    s_cbranch_scc1 L_fin
    s_add_u32 m0, s58, 0
    s_add_u32 s49, s56, 0
    buffer_load_dwordx4 v15, s[16:19], s49 offen lds
    s_add_u32 m0, s58, 1024
    s_add_u32 s49, s56, 7168
    buffer_load_dwordx4 v15, s[16:19], s49 offen lds
    s_add_u32 m0, s58, 2048
    s_add_u32 s49, s56, 14336
    buffer_load_dwordx4 v15, s[16:19], s49 offen lds
    s_add_u32 m0, s58, 3072
    s_add_u32 s49, s56, 21504
    buffer_load_dwordx4 v15, s[16:19], s49 offen lds
    s_add_u32 m0, s58, 4096
    s_add_u32 s49, s56, 28672
    buffer_load_dwordx4 v15, s[16:19], s49 offen lds
    s_add_u32 m0, s58, 5120
    s_add_u32 s49, s56, 35840
    buffer_load_dwordx4 v15, s[16:19], s49 offen lds
    s_add_u32 m0, s58, 6144
    s_add_u32 s49, s56, 43008
    buffer_load_dwordx4 v15, s[16:19], s49 offen lds
    s_add_u32 m0, s58, 7168
    s_add_u32 s49, s56, 50176
    buffer_load_dwordx4 v15, s[16:19], s49 offen lds
    s_add_u32 m0, s58, 8192
    s_add_u32 s49, s56, 57344
    buffer_load_dwordx4 v15, s[16:19], s49 offen lds
    s_add_u32 m0, s58, 9216
    s_add_u32 s49, s56, 64512
    buffer_load_dwordx4 v15, s[16:19], s49 offen lds
    s_add_u32 m0, s58, 10240
    s_add_u32 s49, s56, 71680
    buffer_load_dwordx4 v15, s[16:19], s49 offen lds
    s_add_u32 m0, s58, 11264
    s_add_u32 s49, s56, 78848
    buffer_load_dwordx4 v15, s[16:19], s49 offen lds
    s_add_u32 m0, s58, 22528
    s_add_u32 s49, s56, 157696
    buffer_load_dwordx4 v15, s[16:19], s49 offen lds
    s_add_u32 m0, s58, 23552
    s_add_u32 s49, s56, 164864
    buffer_load_dwordx4 v15, s[16:19], s49 offen lds
    s_add_u32 m0, s58, 24576
    s_add_u32 s49, s56, 172032
    buffer_load_dwordx4 v15, s[16:19], s49 offen lds
    s_add_u32 m0, s58, 25600
    s_add_u32 s49, s56, 179200
    buffer_load_dwordx4 v15, s[16:19], s49 offen lds
    s_add_u32 m0, s58, 26624
    s_add_u32 s49, s56, 186368
    buffer_load_dwordx4 v15, s[16:19], s49 offen lds
    s_add_u32 m0, s58, 27648
    s_add_u32 s49, s56, 193536
    buffer_load_dwordx4 v15, s[16:19], s49 offen lds
    s_lshr_b32 s86, s24, 2
    s_lshl_b32 s46, s51, 1
    s_add_u32 s46, s46, s86
    s_lshl_b32 s89, s46, 7
    s_add_u32 s89, s89, 10571776
    s_mul_i32 s88, s46, 28672
    s_lshl_b32 s47, s52, 7
    s_add_u32 s88, s88, s47
    s_lshl_b32 s47, s20, 5
    s_add_u32 s88, s88, s47
    s_lshl_b32 s46, s46, 5
    s_lshl_b32 s47, s20, 3
    s_add_u32 s46, s46, s47
    s_lshl_b32 s46, s46, 11
    s_add_u32 s87, s46, 6307840
    s_mov_b32 s8, s40
    s_and_b32 s9, s41, 0xffff
    s_mov_b32 s10, 1835008
    s_mov_b32 s11, 0x20000
    v_bfe_u32 v142, v1, 2, 2
    v_lshrrev_b32 v147, 5, v1
    v_lshl_add_u32 v143, v147, 2, v142
    v_lshlrev_b32 v143, 7, v143
    s_mul_i32 s47, s20, 28672
    v_add_u32 v143, s47, v143
    v_and_b32 v144, 1, v1
    v_lshl_add_u32 v143, v144, 3, v143
    v_bfe_u32 v144, v1, 4, 1
    v_lshlrev_b32 v144, 1, v144
    v_bfe_u32 v145, v1, 1, 1
    v_or_b32 v144, v144, v145
    v_lshrrev_b32 v145, 1, v142
    v_lshlrev_b32 v145, 2, v145
    v_or_b32 v146, v144, v145
    v_lshl_add_u32 v128, v146, 4, v143
    v_xor_b32 v145, 4, v145
    v_or_b32 v146, v144, v145
    v_lshl_add_u32 v129, v146, 4, v143
    v_lshlrev_b32 v147, 9, v147
    v_sub_u32 v130, v128, v147
    v_sub_u32 v131, v129, v147
    s_mul_i32 s46, s86, 24576
    s_add_u32 s46, s46, 114688
    v_add_u32 v132, s46, v2
    s_mul_i32 s47, s20, 6144
    v_add_u32 v133, s47, v132
    v_and_b32 v142, 31, v1
    v_lshlrev_b32 v136, 2, v142
    v_mul_u32_u24 v134, 896, v142
    v_lshrrev_b32 v143, 5, v1
    v_lshl_add_u32 v134, v143, 4, v134
    s_cmp_lg_u32 s20, 0
    s_cbranch_scc1 L_noow_38
    s_lshl_b32 s46, s22, 4
    v_add_u32 v5, s46, v1
    v_lshlrev_b32 v5, 7, v5
    v_add_u32 v5, 10649600, v5
    s_mov_b32 s84, 0xffff
    s_mov_b32 s85, 0
    s_cmp_eq_u64 s[84:85], 0
    s_cbranch_scc1 L_polled_40
    s_mov_b32 s63, 262144
    s_mov_b64 exec, s[84:85]
L_poll_39:
    buffer_load_dword v6, v5, s[12:15], 0 offen sc1
    s_waitcnt vmcnt(0)
    v_cmp_ne_u32 vcc, s53, v6
    s_sub_u32 s63, s63, 1
    s_cbranch_scc1 L_polled_40
    s_cmp_lg_u64 vcc, 0
    s_cbranch_scc1 L_poll_39
L_polled_40:
    s_mov_b64 exec, -1
L_noow_38:
    s_waitcnt vmcnt(0)
    s_barrier
    s_branch L_final
L_compute:
    v_and_b32 v3, 31, v1
    v_lshrrev_b32 v4, 5, v1
    s_lshl_b32 s46, s20, 12
    s_add_u32 s46, s46, 35840
    v_lshlrev_b32 v5, 7, v3
    v_add_u32 v5, s46, v5
    v_bfe_u32 v6, v3, 1, 3
    v_add_u32 v7, 0, v4
    v_xor_b32 v7, v7, v6
    v_lshl_add_u32 v244, v7, 4, v5
    v_add_u32 v7, 2, v4
    v_xor_b32 v7, v7, v6
    v_lshl_add_u32 v245, v7, 4, v5
    v_add_u32 v7, 4, v4
    v_xor_b32 v7, v7, v6
    v_lshl_add_u32 v246, v7, 4, v5
    v_add_u32 v7, 6, v4
    v_xor_b32 v7, v7, v6
    v_lshl_add_u32 v247, v7, 4, v5
    v_bfe_u32 v5, v1, 2, 2
    v_lshlrev_b32 v5, 1, v5
    v_add_u32 v5, v5, v4
    v_lshlrev_b32 v5, 1, v5
    v_mul_u32_u24 v5, 112, v5
    v_bfe_u32 v6, v1, 4, 1
    v_lshl_add_u32 v5, v6, 5, v5
    v_and_b32 v6, 3, v1
    v_lshl_add_u32 v5, v6, 3, v5
    v_add_u32 v248, 101376, v5
    v_add_u32 v249, 0, v5
    v_add_u32 v250, 84992, v5
    v_lshlrev_b32 v253, 4, v4
    v_add_u32 v253, 99328, v253
    s_lshr_b32 s46, s2, 6
    s_lshl_b32 s46, s46, 1
    s_bfe_u32 s43, s2, 0x30003
    s_add_u32 s43, s46, s43
    s_sub_u32 s46, s43, 7
    s_cmp_ge_u32 s43, 7
    s_cselect_b32 s43, s46, s43
    s_lshl_b32 s50, s21, 3
    s_add_u32 s50, s50, s23
    s_lshl_b32 s51, s22, 1
    s_lshr_b32 s52, s23, 2
    s_add_u32 s51, s51, s52
    s_bfe_u32 s52, s2, 0x30003
    s_waitcnt lgkmcnt(0)
    s_mov_b32 s12, s82
    s_and_b32 s13, s83, 0xffff
    s_mov_b32 s14, 13631488
    s_mov_b32 s15, 0x20000
    s_mov_b32 s96, s80
    s_and_b32 s97, s81, 0xffff
    s_mov_b32 s98, 256
    s_mov_b32 s99, 0x20000
    s_mov_b32 s40, s78
    s_mov_b32 s41, s79
    s_or_b32 s46, s2, s20
    s_cmp_lg_u32 s46, 0
    s_cbranch_scc1 L_nononce_41
    s_memrealtime s[46:47]
    s_waitcnt lgkmcnt(0)
    s_or_b32 s46, s46, 1
    v_mov_b32 v3, s46
    v_mov_b32 v4, 0
    s_mov_b64 exec, 1
    buffer_store_dword v3, v4, s[96:99], 0 offen sc1
    s_mov_b64 exec, -1
L_nononce_41:
    s_or_b32 s46, s21, s22
    s_or_b32 s46, s46, s20
    s_cmp_lg_u32 s46, 0
    s_cbranch_scc1 L_nozero_42
    v_mov_b32 v4, 0
    v_mov_b32 v5, 0
    v_mov_b32 v6, 0
    v_mov_b32 v7, 0
    s_lshl_b32 s46, s23, 13
    s_add_u32 s46, s46, 10506240
    buffer_store_dwordx4 v[4:7], v2, s[12:15], s46 offen sc1
    s_add_u32 s46, s46, 1024
    buffer_store_dwordx4 v[4:7], v2, s[12:15], s46 offen sc1
    s_add_u32 s46, s46, 1024
    buffer_store_dwordx4 v[4:7], v2, s[12:15], s46 offen sc1
    s_add_u32 s46, s46, 1024
    buffer_store_dwordx4 v[4:7], v2, s[12:15], s46 offen sc1
    s_add_u32 s46, s46, 1024
    buffer_store_dwordx4 v[4:7], v2, s[12:15], s46 offen sc1
    s_add_u32 s46, s46, 1024
    buffer_store_dwordx4 v[4:7], v2, s[12:15], s46 offen sc1
    s_add_u32 s46, s46, 1024
    buffer_store_dwordx4 v[4:7], v2, s[12:15], s46 offen sc1
    s_add_u32 s46, s46, 1024
    buffer_store_dwordx4 v[4:7], v2, s[12:15], s46 offen sc1
    s_add_u32 s46, s46, 1024
    s_waitcnt vmcnt(0)
    s_lshl_b32 s46, s23, 2
    s_add_u32 s46, s46, 32
    v_mov_b32 v3, 1
    v_mov_b32 v4, 0
    s_mov_b64 exec, 1
    buffer_store_dword v3, v4, s[96:99], s46 offen sc1
    s_mov_b64 exec, -1
L_nozero_42:
    s_waitcnt lgkmcnt(0)
    s_barrier
    s_cmp_eq_u32 s21, 0
    s_cbranch_scc1 L_lin
    ds_read_b128 v[112:115], v244 offset:0
    ds_read_b64_tr_b16 v[80:81], v248 offset:0
    ds_read_b64_tr_b16 v[82:83], v248 offset:112
    ds_read_b64_tr_b16 v[84:85], v248 offset:56
    ds_read_b64_tr_b16 v[86:87], v248 offset:168
    ds_read_b64_tr_b16 v[88:89], v248 offset:7168
    ds_read_b64_tr_b16 v[90:91], v248 offset:7280
    ds_read_b64_tr_b16 v[92:93], v248 offset:7224
    ds_read_b64_tr_b16 v[94:95], v248 offset:7336
    ds_read_b128 v[116:119], v245 offset:0
    ds_read_b64_tr_b16 v[96:97], v248 offset:1792
    ds_read_b64_tr_b16 v[98:99], v248 offset:1904
    s_waitcnt lgkmcnt(9)
    v_mfma_f32_32x32x16_bf16 v[16:31], v[80:83], v[112:115], 0
    ds_read_b64_tr_b16 v[100:101], v248 offset:1848
    ds_read_b64_tr_b16 v[102:103], v248 offset:1960
    ds_read_b64_tr_b16 v[104:105], v248 offset:8960
    ds_read_b64_tr_b16 v[106:107], v248 offset:9072
    s_waitcnt lgkmcnt(11)
    v_mfma_f32_32x32x16_bf16 v[32:47], v[84:87], v[112:115], 0
    ds_read_b64_tr_b16 v[108:109], v248 offset:9016
    ds_read_b64_tr_b16 v[110:111], v248 offset:9128
    s_waitcnt lgkmcnt(11)
    v_mfma_f32_32x32x16_bf16 v[48:63], v[112:115], v[88:91], 0
    s_waitcnt lgkmcnt(9)
    v_mfma_f32_32x32x16_bf16 v[64:79], v[112:115], v[92:95], 0
    ds_read_b128 v[120:123], v246 offset:0
    ds_read_b64_tr_b16 v[80:81], v248 offset:3584
    ds_read_b64_tr_b16 v[82:83], v248 offset:3696
    s_waitcnt lgkmcnt(9)
    v_mfma_f32_32x32x16_bf16 v[16:31], v[96:99], v[116:119], v[16:31]
    ds_read_b64_tr_b16 v[84:85], v248 offset:3640
    ds_read_b64_tr_b16 v[86:87], v248 offset:3752
    ds_read_b64_tr_b16 v[88:89], v248 offset:10752
    ds_read_b64_tr_b16 v[90:91], v248 offset:10864
    s_waitcnt lgkmcnt(11)
    v_mfma_f32_32x32x16_bf16 v[32:47], v[100:103], v[116:119], v[32:47]
    ds_read_b64_tr_b16 v[92:93], v248 offset:10808
    ds_read_b64_tr_b16 v[94:95], v248 offset:10920
    s_waitcnt lgkmcnt(11)
    v_mfma_f32_32x32x16_bf16 v[48:63], v[116:119], v[104:107], v[48:63]
    s_waitcnt lgkmcnt(9)
    v_mfma_f32_32x32x16_bf16 v[64:79], v[116:119], v[108:111], v[64:79]
    ds_read_b128 v[124:127], v247 offset:0
    ds_read_b64_tr_b16 v[96:97], v248 offset:5376
    ds_read_b64_tr_b16 v[98:99], v248 offset:5488
    s_waitcnt lgkmcnt(9)
    v_mfma_f32_32x32x16_bf16 v[16:31], v[80:83], v[120:123], v[16:31]
    ds_read_b64_tr_b16 v[100:101], v248 offset:5432
    ds_read_b64_tr_b16 v[102:103], v248 offset:5544
    ds_read_b64_tr_b16 v[104:105], v248 offset:12544
    ds_read_b64_tr_b16 v[106:107], v248 offset:12656
    s_waitcnt lgkmcnt(11)
    v_mfma_f32_32x32x16_bf16 v[32:47], v[84:87], v[120:123], v[32:47]
    ds_read_b64_tr_b16 v[108:109], v248 offset:12600
    ds_read_b64_tr_b16 v[110:111], v248 offset:12712
    s_waitcnt lgkmcnt(11)
    v_mfma_f32_32x32x16_bf16 v[48:63], v[120:123], v[88:91], v[48:63]
    s_waitcnt lgkmcnt(9)
    v_mfma_f32_32x32x16_bf16 v[64:79], v[120:123], v[92:95], v[64:79]
    s_barrier
    ds_read_b128 v[128:131], v244 offset:16384
    ds_read_b64_tr_b16 v[80:81], v248 offset:14336
    ds_read_b64_tr_b16 v[82:83], v248 offset:14448
    s_waitcnt lgkmcnt(9)
    v_mfma_f32_32x32x16_bf16 v[16:31], v[96:99], v[124:127], v[16:31]
    ds_read_b64_tr_b16 v[84:85], v248 offset:14392
    ds_read_b64_tr_b16 v[86:87], v248 offset:14504
    ds_read_b64_tr_b16 v[88:89], v248 offset:21504
    ds_read_b64_tr_b16 v[90:91], v248 offset:21616
    s_waitcnt lgkmcnt(11)
    v_mfma_f32_32x32x16_bf16 v[32:47], v[100:103], v[124:127], v[32:47]
    ds_read_b64_tr_b16 v[92:93], v248 offset:21560
    ds_read_b64_tr_b16 v[94:95], v248 offset:21672
    s_waitcnt lgkmcnt(11)
    v_mfma_f32_32x32x16_bf16 v[48:63], v[124:127], v[104:107], v[48:63]
    s_waitcnt lgkmcnt(9)
    v_mfma_f32_32x32x16_bf16 v[64:79], v[124:127], v[108:111], v[64:79]
    ds_read_b128 v[132:135], v245 offset:16384
    ds_read_b64_tr_b16 v[96:97], v248 offset:16128
    ds_read_b64_tr_b16 v[98:99], v248 offset:16240
    s_waitcnt lgkmcnt(9)
    v_mfma_f32_32x32x16_bf16 v[16:31], v[80:83], v[128:131], v[16:31]
    ds_read_b64_tr_b16 v[100:101], v248 offset:16184
    ds_read_b64_tr_b16 v[102:103], v248 offset:16296
    ds_read_b64_tr_b16 v[104:105], v248 offset:23296
    ds_read_b64_tr_b16 v[106:107], v248 offset:23408
    s_waitcnt lgkmcnt(11)
    v_mfma_f32_32x32x16_bf16 v[32:47], v[84:87], v[128:131], v[32:47]
    ds_read_b64_tr_b16 v[108:109], v248 offset:23352
    ds_read_b64_tr_b16 v[110:111], v248 offset:23464
    s_waitcnt lgkmcnt(11)
    v_mfma_f32_32x32x16_bf16 v[48:63], v[128:131], v[88:91], v[48:63]
    s_waitcnt lgkmcnt(9)
    v_mfma_f32_32x32x16_bf16 v[64:79], v[128:131], v[92:95], v[64:79]
    ds_read_b128 v[136:139], v246 offset:16384
    ds_read_b64_tr_b16 v[80:81], v248 offset:17920
    ds_read_b64_tr_b16 v[82:83], v248 offset:18032
    s_waitcnt lgkmcnt(9)
    v_mfma_f32_32x32x16_bf16 v[16:31], v[96:99], v[132:135], v[16:31]
    ds_read_b64_tr_b16 v[84:85], v248 offset:17976
    ds_read_b64_tr_b16 v[86:87], v248 offset:18088
    ds_read_b64_tr_b16 v[88:89], v248 offset:25088
    ds_read_b64_tr_b16 v[90:91], v248 offset:25200
    s_waitcnt lgkmcnt(11)
    v_mfma_f32_32x32x16_bf16 v[32:47], v[100:103], v[132:135], v[32:47]
    ds_read_b64_tr_b16 v[92:93], v248 offset:25144
    ds_read_b64_tr_b16 v[94:95], v248 offset:25256
    s_waitcnt lgkmcnt(11)
    v_mfma_f32_32x32x16_bf16 v[48:63], v[132:135], v[104:107], v[48:63]
    s_waitcnt lgkmcnt(9)
    v_mfma_f32_32x32x16_bf16 v[64:79], v[132:135], v[108:111], v[64:79]
    ds_read_b128 v[140:143], v247 offset:16384
    ds_read_b64_tr_b16 v[96:97], v248 offset:19712
    ds_read_b64_tr_b16 v[98:99], v248 offset:19824
    s_waitcnt lgkmcnt(9)
    v_mfma_f32_32x32x16_bf16 v[16:31], v[80:83], v[136:139], v[16:31]
    ds_read_b64_tr_b16 v[100:101], v248 offset:19768
    ds_read_b64_tr_b16 v[102:103], v248 offset:19880
    ds_read_b64_tr_b16 v[104:105], v248 offset:26880
    ds_read_b64_tr_b16 v[106:107], v248 offset:26992
    s_waitcnt lgkmcnt(11)
    v_mfma_f32_32x32x16_bf16 v[32:47], v[84:87], v[136:139], v[32:47]
    ds_read_b64_tr_b16 v[108:109], v248 offset:26936
    ds_read_b64_tr_b16 v[110:111], v248 offset:27048
    s_waitcnt lgkmcnt(11)
    v_mfma_f32_32x32x16_bf16 v[48:63], v[136:139], v[88:91], v[48:63]
    s_waitcnt lgkmcnt(9)
    v_mfma_f32_32x32x16_bf16 v[64:79], v[136:139], v[92:95], v[64:79]
    s_barrier
    ds_read_b128 v[144:147], v244 offset:32768
    ds_read_b64_tr_b16 v[80:81], v248 offset:28672
    ds_read_b64_tr_b16 v[82:83], v248 offset:28784
    s_waitcnt lgkmcnt(9)
    v_mfma_f32_32x32x16_bf16 v[16:31], v[96:99], v[140:143], v[16:31]
    ds_read_b64_tr_b16 v[84:85], v248 offset:28728
    ds_read_b64_tr_b16 v[86:87], v248 offset:28840
    ds_read_b64_tr_b16 v[88:89], v248 offset:35840
    ds_read_b64_tr_b16 v[90:91], v248 offset:35952
    s_waitcnt lgkmcnt(11)
    v_mfma_f32_32x32x16_bf16 v[32:47], v[100:103], v[140:143], v[32:47]
    ds_read_b64_tr_b16 v[92:93], v248 offset:35896
    ds_read_b64_tr_b16 v[94:95], v248 offset:36008
    s_waitcnt lgkmcnt(11)
    v_mfma_f32_32x32x16_bf16 v[48:63], v[140:143], v[104:107], v[48:63]
    s_waitcnt lgkmcnt(9)
    v_mfma_f32_32x32x16_bf16 v[64:79], v[140:143], v[108:111], v[64:79]
    ds_read_b128 v[148:151], v245 offset:32768
    ds_read_b64_tr_b16 v[96:97], v248 offset:30464
    ds_read_b64_tr_b16 v[98:99], v248 offset:30576
    s_waitcnt lgkmcnt(9)
    v_mfma_f32_32x32x16_bf16 v[16:31], v[80:83], v[144:147], v[16:31]
    ds_read_b64_tr_b16 v[100:101], v248 offset:30520
    ds_read_b64_tr_b16 v[102:103], v248 offset:30632
    ds_read_b64_tr_b16 v[104:105], v248 offset:37632
    ds_read_b64_tr_b16 v[106:107], v248 offset:37744
    s_waitcnt lgkmcnt(11)
    v_mfma_f32_32x32x16_bf16 v[32:47], v[84:87], v[144:147], v[32:47]
    ds_read_b64_tr_b16 v[108:109], v248 offset:37688
    ds_read_b64_tr_b16 v[110:111], v248 offset:37800
    s_waitcnt lgkmcnt(11)
    v_mfma_f32_32x32x16_bf16 v[48:63], v[144:147], v[88:91], v[48:63]
    s_waitcnt lgkmcnt(9)
    v_mfma_f32_32x32x16_bf16 v[64:79], v[144:147], v[92:95], v[64:79]
    ds_read_b128 v[152:155], v246 offset:32768
    ds_read_b64_tr_b16 v[80:81], v248 offset:32256
    ds_read_b64_tr_b16 v[82:83], v248 offset:32368
    s_waitcnt lgkmcnt(9)
    v_mfma_f32_32x32x16_bf16 v[16:31], v[96:99], v[148:151], v[16:31]
    ds_read_b64_tr_b16 v[84:85], v248 offset:32312
    ds_read_b64_tr_b16 v[86:87], v248 offset:32424
    ds_read_b64_tr_b16 v[88:89], v248 offset:39424
    ds_read_b64_tr_b16 v[90:91], v248 offset:39536
    s_waitcnt lgkmcnt(11)
    v_mfma_f32_32x32x16_bf16 v[32:47], v[100:103], v[148:151], v[32:47]
    ds_read_b64_tr_b16 v[92:93], v248 offset:39480
    ds_read_b64_tr_b16 v[94:95], v248 offset:39592
    s_waitcnt lgkmcnt(11)
    v_mfma_f32_32x32x16_bf16 v[48:63], v[148:151], v[104:107], v[48:63]
    s_waitcnt lgkmcnt(9)
    v_mfma_f32_32x32x16_bf16 v[64:79], v[148:151], v[108:111], v[64:79]
    ds_read_b128 v[156:159], v247 offset:32768
    ds_read_b64_tr_b16 v[96:97], v248 offset:34048
    ds_read_b64_tr_b16 v[98:99], v248 offset:34160
    s_waitcnt lgkmcnt(9)
    v_mfma_f32_32x32x16_bf16 v[16:31], v[80:83], v[152:155], v[16:31]
    ds_read_b64_tr_b16 v[100:101], v248 offset:34104
    ds_read_b64_tr_b16 v[102:103], v248 offset:34216
    ds_read_b64_tr_b16 v[104:105], v248 offset:41216
    ds_read_b64_tr_b16 v[106:107], v248 offset:41328
    s_waitcnt lgkmcnt(11)
    v_mfma_f32_32x32x16_bf16 v[32:47], v[84:87], v[152:155], v[32:47]
    ds_read_b64_tr_b16 v[108:109], v248 offset:41272
    ds_read_b64_tr_b16 v[110:111], v248 offset:41384
    s_waitcnt lgkmcnt(11)
    v_mfma_f32_32x32x16_bf16 v[48:63], v[152:155], v[88:91], v[48:63]
    s_waitcnt lgkmcnt(9)
    v_mfma_f32_32x32x16_bf16 v[64:79], v[152:155], v[92:95], v[64:79]
    s_barrier
    ds_read_b128 v[160:163], v244 offset:49152
    ds_read_b64_tr_b16 v[80:81], v248 offset:43008
    ds_read_b64_tr_b16 v[82:83], v248 offset:43120
    s_waitcnt lgkmcnt(9)
    v_mfma_f32_32x32x16_bf16 v[16:31], v[96:99], v[156:159], v[16:31]
    ds_read_b64_tr_b16 v[84:85], v248 offset:43064
    ds_read_b64_tr_b16 v[86:87], v248 offset:43176
    ds_read_b64_tr_b16 v[88:89], v248 offset:50176
    ds_read_b64_tr_b16 v[90:91], v248 offset:50288
    s_waitcnt lgkmcnt(11)
    v_mfma_f32_32x32x16_bf16 v[32:47], v[100:103], v[156:159], v[32:47]
    ds_read_b64_tr_b16 v[92:93], v248 offset:50232
    ds_read_b64_tr_b16 v[94:95], v248 offset:50344
    s_waitcnt lgkmcnt(11)
    v_mfma_f32_32x32x16_bf16 v[48:63], v[156:159], v[104:107], v[48:63]
    s_waitcnt lgkmcnt(9)
    v_mfma_f32_32x32x16_bf16 v[64:79], v[156:159], v[108:111], v[64:79]
    ds_read_b128 v[164:167], v245 offset:49152
    ds_read_b64_tr_b16 v[96:97], v248 offset:44800
    ds_read_b64_tr_b16 v[98:99], v248 offset:44912
    s_waitcnt lgkmcnt(9)
    v_mfma_f32_32x32x16_bf16 v[16:31], v[80:83], v[160:163], v[16:31]
    ds_read_b64_tr_b16 v[100:101], v248 offset:44856
    ds_read_b64_tr_b16 v[102:103], v248 offset:44968
    ds_read_b64_tr_b16 v[104:105], v248 offset:51968
    ds_read_b64_tr_b16 v[106:107], v248 offset:52080
    s_waitcnt lgkmcnt(11)
    v_mfma_f32_32x32x16_bf16 v[32:47], v[84:87], v[160:163], v[32:47]
    ds_read_b64_tr_b16 v[108:109], v248 offset:52024
    ds_read_b64_tr_b16 v[110:111], v248 offset:52136
    s_waitcnt lgkmcnt(11)
    v_mfma_f32_32x32x16_bf16 v[48:63], v[160:163], v[88:91], v[48:63]
    s_waitcnt lgkmcnt(9)
    v_mfma_f32_32x32x16_bf16 v[64:79], v[160:163], v[92:95], v[64:79]
    ds_read_b128 v[168:171], v246 offset:49152
    ds_read_b64_tr_b16 v[80:81], v248 offset:46592
    ds_read_b64_tr_b16 v[82:83], v248 offset:46704
    s_waitcnt lgkmcnt(9)
    v_mfma_f32_32x32x16_bf16 v[16:31], v[96:99], v[164:167], v[16:31]
    ds_read_b64_tr_b16 v[84:85], v248 offset:46648
    ds_read_b64_tr_b16 v[86:87], v248 offset:46760
    ds_read_b64_tr_b16 v[88:89], v248 offset:53760
    ds_read_b64_tr_b16 v[90:91], v248 offset:53872
    s_waitcnt lgkmcnt(11)
    v_mfma_f32_32x32x16_bf16 v[32:47], v[100:103], v[164:167], v[32:47]
    ds_read_b64_tr_b16 v[92:93], v248 offset:53816
    ds_read_b64_tr_b16 v[94:95], v248 offset:53928
    s_waitcnt lgkmcnt(11)
    v_mfma_f32_32x32x16_bf16 v[48:63], v[164:167], v[104:107], v[48:63]
    s_waitcnt lgkmcnt(9)
    v_mfma_f32_32x32x16_bf16 v[64:79], v[164:167], v[108:111], v[64:79]
    ds_read_b128 v[172:175], v247 offset:49152
    ds_read_b64_tr_b16 v[96:97], v248 offset:48384
    ds_read_b64_tr_b16 v[98:99], v248 offset:48496
    s_waitcnt lgkmcnt(9)
    v_mfma_f32_32x32x16_bf16 v[16:31], v[80:83], v[168:171], v[16:31]
    ds_read_b64_tr_b16 v[100:101], v248 offset:48440
    ds_read_b64_tr_b16 v[102:103], v248 offset:48552
    ds_read_b64_tr_b16 v[104:105], v248 offset:55552
    ds_read_b64_tr_b16 v[106:107], v248 offset:55664
    s_waitcnt lgkmcnt(11)
    v_mfma_f32_32x32x16_bf16 v[32:47], v[84:87], v[168:171], v[32:47]
    ds_read_b64_tr_b16 v[108:109], v248 offset:55608
    ds_read_b64_tr_b16 v[110:111], v248 offset:55720
    s_waitcnt lgkmcnt(11)
    v_mfma_f32_32x32x16_bf16 v[48:63], v[168:171], v[88:91], v[48:63]
    s_waitcnt lgkmcnt(9)
    v_mfma_f32_32x32x16_bf16 v[64:79], v[168:171], v[92:95], v[64:79]
    s_barrier
    ds_read_b128 v[176:179], v244 offset:0
    ds_read_b64_tr_b16 v[80:81], v248 offset:0
    ds_read_b64_tr_b16 v[82:83], v248 offset:112
    s_waitcnt lgkmcnt(9)
    v_mfma_f32_32x32x16_bf16 v[16:31], v[96:99], v[172:175], v[16:31]
    ds_read_b64_tr_b16 v[84:85], v248 offset:56
    ds_read_b64_tr_b16 v[86:87], v248 offset:168
    ds_read_b64_tr_b16 v[88:89], v248 offset:7168
    ds_read_b64_tr_b16 v[90:91], v248 offset:7280
    s_waitcnt lgkmcnt(11)
    v_mfma_f32_32x32x16_bf16 v[32:47], v[100:103], v[172:175], v[32:47]
    ds_read_b64_tr_b16 v[92:93], v248 offset:7224
    ds_read_b64_tr_b16 v[94:95], v248 offset:7336
    s_waitcnt lgkmcnt(11)
    v_mfma_f32_32x32x16_bf16 v[48:63], v[172:175], v[104:107], v[48:63]
    s_waitcnt lgkmcnt(9)
    v_mfma_f32_32x32x16_bf16 v[64:79], v[172:175], v[108:111], v[64:79]
    ds_read_b128 v[180:183], v245 offset:0
    ds_read_b64_tr_b16 v[96:97], v248 offset:1792
    ds_read_b64_tr_b16 v[98:99], v248 offset:1904
    s_waitcnt lgkmcnt(9)
    v_mfma_f32_32x32x16_bf16 v[16:31], v[80:83], v[176:179], v[16:31]
    ds_read_b64_tr_b16 v[100:101], v248 offset:1848
    ds_read_b64_tr_b16 v[102:103], v248 offset:1960
    ds_read_b64_tr_b16 v[104:105], v248 offset:8960
    ds_read_b64_tr_b16 v[106:107], v248 offset:9072
    s_waitcnt lgkmcnt(11)
    v_mfma_f32_32x32x16_bf16 v[32:47], v[84:87], v[176:179], v[32:47]
    ds_read_b64_tr_b16 v[108:109], v248 offset:9016
    ds_read_b64_tr_b16 v[110:111], v248 offset:9128
    s_waitcnt lgkmcnt(11)
    v_mfma_f32_32x32x16_bf16 v[48:63], v[176:179], v[88:91], v[48:63]
    s_waitcnt lgkmcnt(9)
    v_mfma_f32_32x32x16_bf16 v[64:79], v[176:179], v[92:95], v[64:79]
    ds_read_b128 v[184:187], v246 offset:0
    ds_read_b64_tr_b16 v[80:81], v248 offset:3584
    ds_read_b64_tr_b16 v[82:83], v248 offset:3696
    s_waitcnt lgkmcnt(9)
    v_mfma_f32_32x32x16_bf16 v[16:31], v[96:99], v[180:183], v[16:31]
    ds_read_b64_tr_b16 v[84:85], v248 offset:3640
    ds_read_b64_tr_b16 v[86:87], v248 offset:3752
    ds_read_b64_tr_b16 v[88:89], v248 offset:10752
    ds_read_b64_tr_b16 v[90:91], v248 offset:10864
    s_waitcnt lgkmcnt(11)
    v_mfma_f32_32x32x16_bf16 v[32:47], v[100:103], v[180:183], v[32:47]
    ds_read_b64_tr_b16 v[92:93], v248 offset:10808
    ds_read_b64_tr_b16 v[94:95], v248 offset:10920
    s_waitcnt lgkmcnt(11)
    v_mfma_f32_32x32x16_bf16 v[48:63], v[180:183], v[104:107], v[48:63]
    s_waitcnt lgkmcnt(9)
    v_mfma_f32_32x32x16_bf16 v[64:79], v[180:183], v[108:111], v[64:79]
    ds_read_b128 v[188:191], v247 offset:0
    ds_read_b64_tr_b16 v[96:97], v248 offset:5376
    ds_read_b64_tr_b16 v[98:99], v248 offset:5488
    s_waitcnt lgkmcnt(9)
    v_mfma_f32_32x32x16_bf16 v[16:31], v[80:83], v[184:187], v[16:31]
    ds_read_b64_tr_b16 v[100:101], v248 offset:5432
    ds_read_b64_tr_b16 v[102:103], v248 offset:5544
    ds_read_b64_tr_b16 v[104:105], v248 offset:12544
    ds_read_b64_tr_b16 v[106:107], v248 offset:12656
    s_waitcnt lgkmcnt(11)
    v_mfma_f32_32x32x16_bf16 v[32:47], v[84:87], v[184:187], v[32:47]
    ds_read_b64_tr_b16 v[108:109], v248 offset:12600
    ds_read_b64_tr_b16 v[110:111], v248 offset:12712
    s_waitcnt lgkmcnt(11)
    v_mfma_f32_32x32x16_bf16 v[48:63], v[184:187], v[88:91], v[48:63]
    s_waitcnt lgkmcnt(9)
    v_mfma_f32_32x32x16_bf16 v[64:79], v[184:187], v[92:95], v[64:79]
    s_barrier
    ds_read_b128 v[192:195], v244 offset:16384
    ds_read_b64_tr_b16 v[80:81], v248 offset:14336
    ds_read_b64_tr_b16 v[82:83], v248 offset:14448
    s_waitcnt lgkmcnt(9)
    v_mfma_f32_32x32x16_bf16 v[16:31], v[96:99], v[188:191], v[16:31]
    ds_read_b64_tr_b16 v[84:85], v248 offset:14392
    ds_read_b64_tr_b16 v[86:87], v248 offset:14504
    ds_read_b64_tr_b16 v[88:89], v248 offset:21504
    ds_read_b64_tr_b16 v[90:91], v248 offset:21616
    s_waitcnt lgkmcnt(11)
    v_mfma_f32_32x32x16_bf16 v[32:47], v[100:103], v[188:191], v[32:47]
    ds_read_b64_tr_b16 v[92:93], v248 offset:21560
    ds_read_b64_tr_b16 v[94:95], v248 offset:21672
    s_waitcnt lgkmcnt(11)
    v_mfma_f32_32x32x16_bf16 v[48:63], v[188:191], v[104:107], v[48:63]
    s_waitcnt lgkmcnt(9)
    v_mfma_f32_32x32x16_bf16 v[64:79], v[188:191], v[108:111], v[64:79]
    ds_read_b128 v[196:199], v245 offset:16384
    ds_read_b64_tr_b16 v[96:97], v248 offset:16128
    ds_read_b64_tr_b16 v[98:99], v248 offset:16240
    s_waitcnt lgkmcnt(9)
    v_mfma_f32_32x32x16_bf16 v[16:31], v[80:83], v[192:195], v[16:31]
    ds_read_b64_tr_b16 v[100:101], v248 offset:16184
    ds_read_b64_tr_b16 v[102:103], v248 offset:16296
    ds_read_b64_tr_b16 v[104:105], v248 offset:23296
    ds_read_b64_tr_b16 v[106:107], v248 offset:23408
    s_waitcnt lgkmcnt(11)
    v_mfma_f32_32x32x16_bf16 v[32:47], v[84:87], v[192:195], v[32:47]
    ds_read_b64_tr_b16 v[108:109], v248 offset:23352
    ds_read_b64_tr_b16 v[110:111], v248 offset:23464
    s_waitcnt lgkmcnt(11)
    v_mfma_f32_32x32x16_bf16 v[48:63], v[192:195], v[88:91], v[48:63]
    s_waitcnt lgkmcnt(9)
    v_mfma_f32_32x32x16_bf16 v[64:79], v[192:195], v[92:95], v[64:79]
    ds_read_b128 v[200:203], v246 offset:16384
    ds_read_b64_tr_b16 v[80:81], v248 offset:17920
    ds_read_b64_tr_b16 v[82:83], v248 offset:18032
    s_waitcnt lgkmcnt(9)
    v_mfma_f32_32x32x16_bf16 v[16:31], v[96:99], v[196:199], v[16:31]
    ds_read_b64_tr_b16 v[84:85], v248 offset:17976
    ds_read_b64_tr_b16 v[86:87], v248 offset:18088
    ds_read_b64_tr_b16 v[88:89], v248 offset:25088
    ds_read_b64_tr_b16 v[90:91], v248 offset:25200
    s_waitcnt lgkmcnt(11)
    v_mfma_f32_32x32x16_bf16 v[32:47], v[100:103], v[196:199], v[32:47]
    ds_read_b64_tr_b16 v[92:93], v248 offset:25144
    ds_read_b64_tr_b16 v[94:95], v248 offset:25256
    s_waitcnt lgkmcnt(11)
    v_mfma_f32_32x32x16_bf16 v[48:63], v[196:199], v[104:107], v[48:63]
    s_waitcnt lgkmcnt(9)
    v_mfma_f32_32x32x16_bf16 v[64:79], v[196:199], v[108:111], v[64:79]
    ds_read_b128 v[204:207], v247 offset:16384
    ds_read_b64_tr_b16 v[96:97], v248 offset:19712
    ds_read_b64_tr_b16 v[98:99], v248 offset:19824
    s_waitcnt lgkmcnt(9)
    v_mfma_f32_32x32x16_bf16 v[16:31], v[80:83], v[200:203], v[16:31]
    ds_read_b64_tr_b16 v[100:101], v248 offset:19768
    ds_read_b64_tr_b16 v[102:103], v248 offset:19880
    ds_read_b64_tr_b16 v[104:105], v248 offset:26880
    ds_read_b64_tr_b16 v[106:107], v248 offset:26992
    s_waitcnt lgkmcnt(11)
    v_mfma_f32_32x32x16_bf16 v[32:47], v[84:87], v[200:203], v[32:47]
    ds_read_b64_tr_b16 v[108:109], v248 offset:26936
    ds_read_b64_tr_b16 v[110:111], v248 offset:27048
    s_waitcnt lgkmcnt(11)
    v_mfma_f32_32x32x16_bf16 v[48:63], v[200:203], v[88:91], v[48:63]
    s_waitcnt lgkmcnt(9)
    v_mfma_f32_32x32x16_bf16 v[64:79], v[200:203], v[92:95], v[64:79]
    s_barrier
    ds_read_b128 v[208:211], v244 offset:32768
    ds_read_b64_tr_b16 v[80:81], v248 offset:28672
    ds_read_b64_tr_b16 v[82:83], v248 offset:28784
    s_waitcnt lgkmcnt(9)
    v_mfma_f32_32x32x16_bf16 v[16:31], v[96:99], v[204:207], v[16:31]
    ds_read_b64_tr_b16 v[84:85], v248 offset:28728
    ds_read_b64_tr_b16 v[86:87], v248 offset:28840
    ds_read_b64_tr_b16 v[88:89], v248 offset:35840
    ds_read_b64_tr_b16 v[90:91], v248 offset:35952
    s_waitcnt lgkmcnt(11)
    v_mfma_f32_32x32x16_bf16 v[32:47], v[100:103], v[204:207], v[32:47]
    ds_read_b64_tr_b16 v[92:93], v248 offset:35896
    ds_read_b64_tr_b16 v[94:95], v248 offset:36008
    s_waitcnt lgkmcnt(11)
    v_mfma_f32_32x32x16_bf16 v[48:63], v[204:207], v[104:107], v[48:63]
    s_waitcnt lgkmcnt(9)
    v_mfma_f32_32x32x16_bf16 v[64:79], v[204:207], v[108:111], v[64:79]
    ds_read_b128 v[212:215], v245 offset:32768
    ds_read_b64_tr_b16 v[96:97], v248 offset:30464
    ds_read_b64_tr_b16 v[98:99], v248 offset:30576
    s_waitcnt lgkmcnt(9)
    v_mfma_f32_32x32x16_bf16 v[16:31], v[80:83], v[208:211], v[16:31]
    ds_read_b64_tr_b16 v[100:101], v248 offset:30520
    ds_read_b64_tr_b16 v[102:103], v248 offset:30632
    ds_read_b64_tr_b16 v[104:105], v248 offset:37632
    ds_read_b64_tr_b16 v[106:107], v248 offset:37744
    s_waitcnt lgkmcnt(11)
    v_mfma_f32_32x32x16_bf16 v[32:47], v[84:87], v[208:211], v[32:47]
    ds_read_b64_tr_b16 v[108:109], v248 offset:37688
    ds_read_b64_tr_b16 v[110:111], v248 offset:37800
    s_waitcnt lgkmcnt(11)
    v_mfma_f32_32x32x16_bf16 v[48:63], v[208:211], v[88:91], v[48:63]
    s_waitcnt lgkmcnt(9)
    v_mfma_f32_32x32x16_bf16 v[64:79], v[208:211], v[92:95], v[64:79]
    ds_read_b128 v[216:219], v246 offset:32768
    ds_read_b64_tr_b16 v[80:81], v248 offset:32256
    ds_read_b64_tr_b16 v[82:83], v248 offset:32368
    s_waitcnt lgkmcnt(9)
    v_mfma_f32_32x32x16_bf16 v[16:31], v[96:99], v[212:215], v[16:31]
    ds_read_b64_tr_b16 v[84:85], v248 offset:32312
    ds_read_b64_tr_b16 v[86:87], v248 offset:32424
    ds_read_b64_tr_b16 v[88:89], v248 offset:39424
    ds_read_b64_tr_b16 v[90:91], v248 offset:39536
    s_waitcnt lgkmcnt(11)
    v_mfma_f32_32x32x16_bf16 v[32:47], v[100:103], v[212:215], v[32:47]
    ds_read_b64_tr_b16 v[92:93], v248 offset:39480
    ds_read_b64_tr_b16 v[94:95], v248 offset:39592
    s_waitcnt lgkmcnt(11)
    v_mfma_f32_32x32x16_bf16 v[48:63], v[212:215], v[104:107], v[48:63]
    s_waitcnt lgkmcnt(9)
    v_mfma_f32_32x32x16_bf16 v[64:79], v[212:215], v[108:111], v[64:79]
    ds_read_b128 v[220:223], v247 offset:32768
    ds_read_b64_tr_b16 v[96:97], v248 offset:34048
    ds_read_b64_tr_b16 v[98:99], v248 offset:34160
    s_waitcnt lgkmcnt(9)
    v_mfma_f32_32x32x16_bf16 v[16:31], v[80:83], v[216:219], v[16:31]
    ds_read_b64_tr_b16 v[100:101], v248 offset:34104
    ds_read_b64_tr_b16 v[102:103], v248 offset:34216
    ds_read_b64_tr_b16 v[104:105], v248 offset:41216
    ds_read_b64_tr_b16 v[106:107], v248 offset:41328
    s_waitcnt lgkmcnt(11)
    v_mfma_f32_32x32x16_bf16 v[32:47], v[84:87], v[216:219], v[32:47]
    ds_read_b64_tr_b16 v[108:109], v248 offset:41272
    ds_read_b64_tr_b16 v[110:111], v248 offset:41384
    s_waitcnt lgkmcnt(11)
    v_mfma_f32_32x32x16_bf16 v[48:63], v[216:219], v[88:91], v[48:63]
    s_waitcnt lgkmcnt(9)
    v_mfma_f32_32x32x16_bf16 v[64:79], v[216:219], v[92:95], v[64:79]
    s_barrier
    s_waitcnt lgkmcnt(6)
    v_mfma_f32_32x32x16_bf16 v[16:31], v[96:99], v[220:223], v[16:31]
    s_waitcnt lgkmcnt(4)
    v_mfma_f32_32x32x16_bf16 v[32:47], v[100:103], v[220:223], v[32:47]
    s_waitcnt lgkmcnt(2)
    v_mfma_f32_32x32x16_bf16 v[48:63], v[220:223], v[104:107], v[48:63]
    s_waitcnt lgkmcnt(0)
    v_mfma_f32_32x32x16_bf16 v[64:79], v[220:223], v[108:111], v[64:79]
    s_barrier
    s_load_dword s53, s[80:81], 0
    s_mov_b32 s44, 0
    s_mov_b32 s45, -1
    s_mov_b32 s54, 0x10000000
    s_mov_b32 s55, 0x10000000
    s_mov_b32 s56, 0xf0000000
    s_mov_b32 s57, 0xf0000000
    v_mov_b32 v240, 0x3f803f80
    v_mov_b32 v241, 0x3f80
    s_lshl_b32 s48, s23, 7
    s_lshl_b32 s47, s22, 2
    s_add_u32 s48, s48, s47
    s_add_u32 s48, s48, s20
    s_lshl_b32 s48, s48, 11
    v_cvt_pk_bf16_f32 v32, v32, v33
    v_cvt_pk_bf16_f32 v33, v34, v35
    v_cvt_pk_bf16_f32 v34, v36, v37
    v_cvt_pk_bf16_f32 v35, v38, v39
    v_cvt_pk_bf16_f32 v36, v40, v41
    v_cvt_pk_bf16_f32 v37, v42, v43
    v_cvt_pk_bf16_f32 v38, v44, v45
    v_cvt_pk_bf16_f32 v39, v46, v47
    v_cndmask_b32_e64 v38, v38, 0, s[44:45]
    v_cndmask_b32_e64 v39, v39, 0, s[44:45]
    s_add_u32 s46, s48, 2232320
    buffer_store_dwordx4 v[32:35], v2, s[12:15], s46 offen offset:0 sc1
    buffer_store_dwordx4 v[36:39], v2, s[12:15], s46 offen offset:1024 sc1
    v_cvt_pk_bf16_f32 v64, v64, v65
    v_cvt_pk_bf16_f32 v65, v66, v67
    v_cvt_pk_bf16_f32 v66, v68, v69
    v_cvt_pk_bf16_f32 v67, v70, v71
    v_cvt_pk_bf16_f32 v68, v72, v73
    v_cvt_pk_bf16_f32 v69, v74, v75
    v_cvt_pk_bf16_f32 v70, v76, v77
    v_cvt_pk_bf16_f32 v71, v78, v79
    v_cndmask_b32_e64 v64, v64, v240, s[54:55]
    v_cndmask_b32_e64 v65, v65, v240, s[54:55]
    v_cndmask_b32_e64 v66, v66, v240, s[54:55]
    v_cndmask_b32_e64 v67, v67, v240, s[54:55]
    v_cndmask_b32_e64 v68, v68, v240, s[54:55]
    v_cndmask_b32_e64 v69, v69, v240, s[54:55]
    v_cndmask_b32_e64 v70, v70, v240, s[54:55]
    v_cndmask_b32_e64 v71, v71, v240, s[54:55]
    s_add_u32 s46, s48, 4333568
    buffer_store_dwordx4 v[64:67], v2, s[12:15], s46 offen offset:0 sc1
    buffer_store_dwordx4 v[68:71], v2, s[12:15], s46 offen offset:1024 sc1
    v_cvt_pk_bf16_f32 v16, v16, v17
    v_cvt_pk_bf16_f32 v17, v18, v19
    v_cvt_pk_bf16_f32 v18, v20, v21
    v_cvt_pk_bf16_f32 v19, v22, v23
    v_cvt_pk_bf16_f32 v20, v24, v25
    v_cvt_pk_bf16_f32 v21, v26, v27
    v_cvt_pk_bf16_f32 v22, v28, v29
    v_cvt_pk_bf16_f32 v23, v30, v31
    v_cndmask_b32_e64 v22, v22, 0, s[44:45]
    v_cndmask_b32_e64 v23, v23, 0, s[44:45]
    s_add_u32 s46, s48, 2101248
    buffer_store_dwordx4 v[16:19], v2, s[12:15], s46 offen offset:0 sc1
    buffer_store_dwordx4 v[20:23], v2, s[12:15], s46 offen offset:1024 sc1
    v_cvt_pk_bf16_f32 v48, v48, v49
    v_cvt_pk_bf16_f32 v49, v50, v51
    v_cvt_pk_bf16_f32 v50, v52, v53
    v_cvt_pk_bf16_f32 v51, v54, v55
    v_cvt_pk_bf16_f32 v52, v56, v57
    v_cvt_pk_bf16_f32 v53, v58, v59
    v_cvt_pk_bf16_f32 v54, v60, v61
    v_cvt_pk_bf16_f32 v55, v62, v63
    v_cndmask_b32_e64 v48, v48, v240, s[54:55]
    v_cndmask_b32_e64 v49, v49, v240, s[54:55]
    v_cndmask_b32_e64 v50, v50, v240, s[54:55]
    v_cndmask_b32_e64 v51, v51, v240, s[54:55]
    v_cndmask_b32_e64 v52, v52, v240, s[54:55]
    v_cndmask_b32_e64 v53, v53, v240, s[54:55]
    v_cndmask_b32_e64 v54, v54, v240, s[54:55]
    v_cndmask_b32_e64 v55, v55, v240, s[54:55]
    s_add_u32 s46, s48, 4202496
    buffer_store_dwordx4 v[48:51], v2, s[12:15], s46 offen offset:0 sc1
    buffer_store_dwordx4 v[52:55], v2, s[12:15], s46 offen offset:1024 sc1
    s_lshl_b32 s46, s20, 12
    s_add_u32 s46, s46, 147456
    v_add_u32 v3, s46, v2
    ds_write_b128 v3, v[16:19]
    ds_write_b128 v3, v[20:23] offset:1024
    ds_write_b128 v3, v[48:51] offset:2048
    ds_write_b128 v3, v[52:55] offset:3072
    s_cmp_lg_u32 s20, 3
    s_cbranch_scc1 L_nocnt_43
    v_mov_b32 v3, 163808
    v_mov_b32 v4, 0
    ds_write_b32 v3, v4
L_nocnt_43:
    s_waitcnt lgkmcnt(0)
    s_barrier
    ds_read_b64_tr_b16 v[80:81], v249 offset:56
    ds_read_b64_tr_b16 v[82:83], v249 offset:168
    ds_read_b64_tr_b16 v[84:85], v249 offset:1848
    ds_read_b64_tr_b16 v[86:87], v249 offset:1960
    ds_read_b64_tr_b16 v[88:89], v249 offset:3640
    ds_read_b64_tr_b16 v[90:91], v249 offset:3752
    ds_read_b64_tr_b16 v[92:93], v249 offset:5432
    ds_read_b64_tr_b16 v[94:95], v249 offset:5544
    ds_read_b64_tr_b16 v[96:97], v249 offset:7224
    ds_read_b64_tr_b16 v[98:99], v249 offset:7336
    ds_read_b64_tr_b16 v[100:101], v249 offset:9016
    ds_read_b64_tr_b16 v[102:103], v249 offset:9128
    ds_read_b64_tr_b16 v[104:105], v249 offset:10808
    ds_read_b64_tr_b16 v[106:107], v249 offset:10920
    s_waitcnt lgkmcnt(12)
    v_mfma_f32_32x32x16_bf16 v[32:47], v[80:83], v[112:115], 0
    ds_read_b64_tr_b16 v[108:109], v249 offset:12600
    ds_read_b64_tr_b16 v[110:111], v249 offset:12712
    s_waitcnt lgkmcnt(12)
    v_mfma_f32_32x32x16_bf16 v[32:47], v[84:87], v[116:119], v[32:47]
    ds_read_b64_tr_b16 v[80:81], v249 offset:14392
    ds_read_b64_tr_b16 v[82:83], v249 offset:14504
    s_waitcnt lgkmcnt(12)
    v_mfma_f32_32x32x16_bf16 v[32:47], v[88:91], v[120:123], v[32:47]
    ds_read_b64_tr_b16 v[84:85], v249 offset:16184
    ds_read_b64_tr_b16 v[86:87], v249 offset:16296
    s_waitcnt lgkmcnt(12)
    v_mfma_f32_32x32x16_bf16 v[32:47], v[92:95], v[124:127], v[32:47]
    ds_read_b64_tr_b16 v[88:89], v249 offset:17976
    ds_read_b64_tr_b16 v[90:91], v249 offset:18088
    s_waitcnt lgkmcnt(12)
    v_mfma_f32_32x32x16_bf16 v[32:47], v[96:99], v[128:131], v[32:47]
    ds_read_b64_tr_b16 v[92:93], v249 offset:19768
    ds_read_b64_tr_b16 v[94:95], v249 offset:19880
    s_waitcnt lgkmcnt(12)
    v_mfma_f32_32x32x16_bf16 v[32:47], v[100:103], v[132:135], v[32:47]
    ds_read_b64_tr_b16 v[96:97], v249 offset:21560
    ds_read_b64_tr_b16 v[98:99], v249 offset:21672
    s_waitcnt lgkmcnt(12)
    v_mfma_f32_32x32x16_bf16 v[32:47], v[104:107], v[136:139], v[32:47]
    ds_read_b64_tr_b16 v[100:101], v249 offset:23352
    ds_read_b64_tr_b16 v[102:103], v249 offset:23464
    s_waitcnt lgkmcnt(12)
    v_mfma_f32_32x32x16_bf16 v[32:47], v[108:111], v[140:143], v[32:47]
    ds_read_b64_tr_b16 v[104:105], v249 offset:25144
    ds_read_b64_tr_b16 v[106:107], v249 offset:25256
    s_waitcnt lgkmcnt(12)
    v_mfma_f32_32x32x16_bf16 v[32:47], v[80:83], v[144:147], v[32:47]
    ds_read_b64_tr_b16 v[108:109], v249 offset:26936
    ds_read_b64_tr_b16 v[110:111], v249 offset:27048
    s_waitcnt lgkmcnt(12)
    v_mfma_f32_32x32x16_bf16 v[32:47], v[84:87], v[148:151], v[32:47]
    ds_read_b64_tr_b16 v[80:81], v249 offset:28728
    ds_read_b64_tr_b16 v[82:83], v249 offset:28840
    s_waitcnt lgkmcnt(12)
    v_mfma_f32_32x32x16_bf16 v[32:47], v[88:91], v[152:155], v[32:47]
    ds_read_b64_tr_b16 v[84:85], v249 offset:30520
    ds_read_b64_tr_b16 v[86:87], v249 offset:30632
    s_waitcnt lgkmcnt(12)
    v_mfma_f32_32x32x16_bf16 v[32:47], v[92:95], v[156:159], v[32:47]
    ds_read_b64_tr_b16 v[88:89], v249 offset:32312
    ds_read_b64_tr_b16 v[90:91], v249 offset:32424
    s_waitcnt lgkmcnt(12)
    v_mfma_f32_32x32x16_bf16 v[32:47], v[96:99], v[160:163], v[32:47]
    ds_read_b64_tr_b16 v[92:93], v249 offset:34104
    ds_read_b64_tr_b16 v[94:95], v249 offset:34216
    s_waitcnt lgkmcnt(12)
    v_mfma_f32_32x32x16_bf16 v[32:47], v[100:103], v[164:167], v[32:47]
    ds_read_b64_tr_b16 v[96:97], v250 offset:56
    ds_read_b64_tr_b16 v[98:99], v250 offset:168
    s_waitcnt lgkmcnt(12)
    v_mfma_f32_32x32x16_bf16 v[32:47], v[104:107], v[168:171], v[32:47]
    ds_read_b64_tr_b16 v[100:101], v250 offset:1848
    ds_read_b64_tr_b16 v[102:103], v250 offset:1960
    s_waitcnt lgkmcnt(12)
    v_mfma_f32_32x32x16_bf16 v[32:47], v[108:111], v[172:175], v[32:47]
    ds_read_b64_tr_b16 v[104:105], v250 offset:3640
    ds_read_b64_tr_b16 v[106:107], v250 offset:3752
    s_waitcnt lgkmcnt(12)
    v_mfma_f32_32x32x16_bf16 v[32:47], v[80:83], v[176:179], v[32:47]
    ds_read_b64_tr_b16 v[108:109], v250 offset:5432
    ds_read_b64_tr_b16 v[110:111], v250 offset:5544
    s_waitcnt lgkmcnt(12)
    v_mfma_f32_32x32x16_bf16 v[32:47], v[84:87], v[180:183], v[32:47]
    ds_read_b64_tr_b16 v[80:81], v250 offset:7224
    ds_read_b64_tr_b16 v[82:83], v250 offset:7336
    s_waitcnt lgkmcnt(12)
    v_mfma_f32_32x32x16_bf16 v[32:47], v[88:91], v[184:187], v[32:47]
    ds_read_b64_tr_b16 v[84:85], v250 offset:9016
    ds_read_b64_tr_b16 v[86:87], v250 offset:9128
    s_waitcnt lgkmcnt(12)
    v_mfma_f32_32x32x16_bf16 v[32:47], v[92:95], v[188:191], v[32:47]
    ds_read_b64_tr_b16 v[88:89], v250 offset:10808
    ds_read_b64_tr_b16 v[90:91], v250 offset:10920
    s_waitcnt lgkmcnt(12)
    v_mfma_f32_32x32x16_bf16 v[32:47], v[96:99], v[192:195], v[32:47]
    ds_read_b64_tr_b16 v[92:93], v250 offset:12600
    ds_read_b64_tr_b16 v[94:95], v250 offset:12712
    s_waitcnt lgkmcnt(12)
    v_mfma_f32_32x32x16_bf16 v[32:47], v[100:103], v[196:199], v[32:47]
    s_waitcnt lgkmcnt(10)
    v_mfma_f32_32x32x16_bf16 v[32:47], v[104:107], v[200:203], v[32:47]
    s_waitcnt lgkmcnt(8)
    v_mfma_f32_32x32x16_bf16 v[32:47], v[108:111], v[204:207], v[32:47]
    s_waitcnt lgkmcnt(6)
    v_mfma_f32_32x32x16_bf16 v[32:47], v[80:83], v[208:211], v[32:47]
    s_waitcnt lgkmcnt(4)
    v_mfma_f32_32x32x16_bf16 v[32:47], v[84:87], v[212:215], v[32:47]
    s_waitcnt lgkmcnt(2)
    v_mfma_f32_32x32x16_bf16 v[32:47], v[88:91], v[216:219], v[32:47]
    s_waitcnt lgkmcnt(0)
    v_mfma_f32_32x32x16_bf16 v[32:47], v[92:95], v[220:223], v[32:47]
    s_nop 7
    s_nop 3
    v_cvt_pk_bf16_f32 v32, v32, v33
    v_cvt_pk_bf16_f32 v33, v34, v35
    v_cvt_pk_bf16_f32 v34, v36, v37
    v_cvt_pk_bf16_f32 v35, v38, v39
    v_cvt_pk_bf16_f32 v36, v40, v41
    v_cvt_pk_bf16_f32 v37, v42, v43
    v_cvt_pk_bf16_f32 v38, v44, v45
    v_cvt_pk_bf16_f32 v39, v46, v47
    v_cndmask_b32_e64 v38, v38, v241, s[44:45]
    v_cndmask_b32_e64 v39, v39, 0, s[44:45]
    s_add_u32 s46, s48, 131072
    buffer_store_dwordx4 v[32:35], v2, s[12:15], s46 offen offset:0 sc1
    buffer_store_dwordx4 v[36:39], v2, s[12:15], s46 offen offset:1024 sc1
    ds_read_b64_tr_b16 v[80:81], v249 offset:0
    ds_read_b64_tr_b16 v[82:83], v249 offset:112
    ds_read_b64_tr_b16 v[84:85], v249 offset:1792
    ds_read_b64_tr_b16 v[86:87], v249 offset:1904
    ds_read_b64_tr_b16 v[88:89], v249 offset:3584
    ds_read_b64_tr_b16 v[90:91], v249 offset:3696
    ds_read_b64_tr_b16 v[92:93], v249 offset:5376
    ds_read_b64_tr_b16 v[94:95], v249 offset:5488
    ds_read_b64_tr_b16 v[96:97], v249 offset:7168
    ds_read_b64_tr_b16 v[98:99], v249 offset:7280
    ds_read_b64_tr_b16 v[100:101], v249 offset:8960
    ds_read_b64_tr_b16 v[102:103], v249 offset:9072
    ds_read_b64_tr_b16 v[104:105], v249 offset:10752
    ds_read_b64_tr_b16 v[106:107], v249 offset:10864
    s_waitcnt lgkmcnt(12)
    v_mfma_f32_32x32x16_bf16 v[16:31], v[80:83], v[112:115], 0
    ds_read_b64_tr_b16 v[108:109], v249 offset:12544
    ds_read_b64_tr_b16 v[110:111], v249 offset:12656
    s_waitcnt lgkmcnt(12)
    v_mfma_f32_32x32x16_bf16 v[16:31], v[84:87], v[116:119], v[16:31]
    ds_read_b64_tr_b16 v[80:81], v249 offset:14336
    ds_read_b64_tr_b16 v[82:83], v249 offset:14448
    s_waitcnt lgkmcnt(12)
    v_mfma_f32_32x32x16_bf16 v[16:31], v[88:91], v[120:123], v[16:31]
    ds_read_b64_tr_b16 v[84:85], v249 offset:16128
    ds_read_b64_tr_b16 v[86:87], v249 offset:16240
    s_waitcnt lgkmcnt(12)
    v_mfma_f32_32x32x16_bf16 v[16:31], v[92:95], v[124:127], v[16:31]
    ds_read_b64_tr_b16 v[88:89], v249 offset:17920
    ds_read_b64_tr_b16 v[90:91], v249 offset:18032
    s_waitcnt lgkmcnt(12)
    v_mfma_f32_32x32x16_bf16 v[16:31], v[96:99], v[128:131], v[16:31]
    ds_read_b64_tr_b16 v[92:93], v249 offset:19712
    ds_read_b64_tr_b16 v[94:95], v249 offset:19824
    s_waitcnt lgkmcnt(12)
    v_mfma_f32_32x32x16_bf16 v[16:31], v[100:103], v[132:135], v[16:31]
    ds_read_b64_tr_b16 v[96:97], v249 offset:21504
    ds_read_b64_tr_b16 v[98:99], v249 offset:21616
    s_waitcnt lgkmcnt(12)
    v_mfma_f32_32x32x16_bf16 v[16:31], v[104:107], v[136:139], v[16:31]
    ds_read_b64_tr_b16 v[100:101], v249 offset:23296
    ds_read_b64_tr_b16 v[102:103], v249 offset:23408
    s_waitcnt lgkmcnt(12)
    v_mfma_f32_32x32x16_bf16 v[16:31], v[108:111], v[140:143], v[16:31]
    ds_read_b64_tr_b16 v[104:105], v249 offset:25088
    ds_read_b64_tr_b16 v[106:107], v249 offset:25200
    s_waitcnt lgkmcnt(12)
    v_mfma_f32_32x32x16_bf16 v[16:31], v[80:83], v[144:147], v[16:31]
    ds_read_b64_tr_b16 v[108:109], v249 offset:26880
    ds_read_b64_tr_b16 v[110:111], v249 offset:26992
    s_waitcnt lgkmcnt(12)
    v_mfma_f32_32x32x16_bf16 v[16:31], v[84:87], v[148:151], v[16:31]
    ds_read_b64_tr_b16 v[80:81], v249 offset:28672
    ds_read_b64_tr_b16 v[82:83], v249 offset:28784
    s_waitcnt lgkmcnt(12)
    v_mfma_f32_32x32x16_bf16 v[16:31], v[88:91], v[152:155], v[16:31]
    ds_read_b64_tr_b16 v[84:85], v249 offset:30464
    ds_read_b64_tr_b16 v[86:87], v249 offset:30576
    s_waitcnt lgkmcnt(12)
    v_mfma_f32_32x32x16_bf16 v[16:31], v[92:95], v[156:159], v[16:31]
    ds_read_b64_tr_b16 v[88:89], v249 offset:32256
    ds_read_b64_tr_b16 v[90:91], v249 offset:32368
    s_waitcnt lgkmcnt(12)
    v_mfma_f32_32x32x16_bf16 v[16:31], v[96:99], v[160:163], v[16:31]
    ds_read_b64_tr_b16 v[92:93], v249 offset:34048
    ds_read_b64_tr_b16 v[94:95], v249 offset:34160
    s_waitcnt lgkmcnt(12)
    v_mfma_f32_32x32x16_bf16 v[16:31], v[100:103], v[164:167], v[16:31]
    ds_read_b64_tr_b16 v[96:97], v250 offset:0
    ds_read_b64_tr_b16 v[98:99], v250 offset:112
    s_waitcnt lgkmcnt(12)
    v_mfma_f32_32x32x16_bf16 v[16:31], v[104:107], v[168:171], v[16:31]
    ds_read_b64_tr_b16 v[100:101], v250 offset:1792
    ds_read_b64_tr_b16 v[102:103], v250 offset:1904
    s_waitcnt lgkmcnt(12)
    v_mfma_f32_32x32x16_bf16 v[16:31], v[108:111], v[172:175], v[16:31]
    ds_read_b64_tr_b16 v[104:105], v250 offset:3584
    ds_read_b64_tr_b16 v[106:107], v250 offset:3696
    s_waitcnt lgkmcnt(12)
    v_mfma_f32_32x32x16_bf16 v[16:31], v[80:83], v[176:179], v[16:31]
    ds_read_b64_tr_b16 v[108:109], v250 offset:5376
    ds_read_b64_tr_b16 v[110:111], v250 offset:5488
    s_waitcnt lgkmcnt(12)
    v_mfma_f32_32x32x16_bf16 v[16:31], v[84:87], v[180:183], v[16:31]
    ds_read_b64_tr_b16 v[80:81], v250 offset:7168
    ds_read_b64_tr_b16 v[82:83], v250 offset:7280
    s_waitcnt lgkmcnt(12)
    v_mfma_f32_32x32x16_bf16 v[16:31], v[88:91], v[184:187], v[16:31]
    ds_read_b64_tr_b16 v[84:85], v250 offset:8960
    ds_read_b64_tr_b16 v[86:87], v250 offset:9072
    s_waitcnt lgkmcnt(12)
    v_mfma_f32_32x32x16_bf16 v[16:31], v[92:95], v[188:191], v[16:31]
    ds_read_b64_tr_b16 v[88:89], v250 offset:10752
    ds_read_b64_tr_b16 v[90:91], v250 offset:10864
    s_waitcnt lgkmcnt(12)
    v_mfma_f32_32x32x16_bf16 v[16:31], v[96:99], v[192:195], v[16:31]
    ds_read_b64_tr_b16 v[92:93], v250 offset:12544
    ds_read_b64_tr_b16 v[94:95], v250 offset:12656
    s_waitcnt lgkmcnt(12)
    v_mfma_f32_32x32x16_bf16 v[16:31], v[100:103], v[196:199], v[16:31]
    s_waitcnt lgkmcnt(10)
    v_mfma_f32_32x32x16_bf16 v[16:31], v[104:107], v[200:203], v[16:31]
    s_waitcnt lgkmcnt(8)
    v_mfma_f32_32x32x16_bf16 v[16:31], v[108:111], v[204:207], v[16:31]
    s_waitcnt lgkmcnt(6)
    v_mfma_f32_32x32x16_bf16 v[16:31], v[80:83], v[208:211], v[16:31]
    s_waitcnt lgkmcnt(4)
    v_mfma_f32_32x32x16_bf16 v[16:31], v[84:87], v[212:215], v[16:31]
    s_waitcnt lgkmcnt(2)
    v_mfma_f32_32x32x16_bf16 v[16:31], v[88:91], v[216:219], v[16:31]
    s_waitcnt lgkmcnt(0)
    v_mfma_f32_32x32x16_bf16 v[16:31], v[92:95], v[220:223], v[16:31]
    s_waitcnt vmcnt(0)
    v_mov_b32 v3, 61444
    v_mov_b32 v4, 1
    s_mov_b64 exec, 1
    ds_add_rtn_u32 v4, v3, v4
    s_mov_b64 exec, -1
    s_waitcnt lgkmcnt(0)
    v_readfirstlane_b32 s46, v4
    s_cmp_lg_u32 s46, 3
    s_cbranch_scc1 L_notlast_44
    s_cmp_lg_u32 s53, 0
    s_cbranch_scc1 L_nok_45
    s_mov_b32 s59, 262144
    v_mov_b32 v4, 0
L_npoll_46:
    buffer_load_dword v3, v4, s[96:99], 0 offen sc1
    s_waitcnt vmcnt(0)
    v_readfirstlane_b32 s53, v3
    s_sub_u32 s59, s59, 1
    s_cbranch_scc1 L_nok_45
    s_cmp_eq_u32 s53, 0
    s_cbranch_scc1 L_npoll_46
L_nok_45:
    s_mul_i32 s46, s22, 8
    s_add_u32 s46, s46, s23
    s_lshl_b32 s46, s46, 7
    s_add_u32 s46, s46, 10616832
    v_mov_b32 v3, s53
    v_mov_b32 v4, 0
    s_mov_b64 exec, 1
    buffer_store_dword v3, v4, s[12:15], s46 offen sc1
    s_mov_b64 exec, -1
L_notlast_44:
    s_nop 3
    v_cvt_pk_bf16_f32 v160, v16, v17
    v_cvt_pk_bf16_f32 v161, v18, v19
    v_cvt_pk_bf16_f32 v162, v20, v21
    v_cvt_pk_bf16_f32 v163, v22, v23
    v_cvt_pk_bf16_f32 v164, v24, v25
    v_cvt_pk_bf16_f32 v165, v26, v27
    v_cvt_pk_bf16_f32 v166, v28, v29
    v_cvt_pk_bf16_f32 v167, v30, v31
    v_cndmask_b32_e64 v166, v166, v241, s[44:45]
    v_cndmask_b32_e64 v167, v167, 0, s[44:45]
    v_and_b32 v3, 31, v1
    v_lshrrev_b32 v4, 5, v1
    v_lshlrev_b32 v4, 2, v4
    v_sub_u32 v205, v3, v4
    v_cmp_le_i32_e64 s[60:61], 0, v205
    v_cmp_le_i32_e64 s[62:63], 1, v205
    v_cmp_le_i32_e64 s[64:65], 2, v205
    v_cmp_le_i32_e64 s[66:67], 3, v205
    v_cmp_le_i32_e64 s[68:69], 8, v205
    v_cmp_le_i32_e64 s[70:71], 9, v205
    v_cmp_le_i32_e64 s[72:73], 10, v205
    v_cmp_le_i32_e64 s[74:75], 11, v205
    v_cmp_le_i32_e64 s[76:77], 16, v205
    v_cmp_le_i32_e64 s[78:79], 17, v205
    v_cmp_le_i32_e64 s[80:81], 18, v205
    v_cmp_le_i32_e64 s[82:83], 19, v205
    v_cmp_le_i32_e64 s[84:85], 24, v205
    v_cmp_le_i32_e64 s[86:87], 25, v205
    v_cmp_le_i32_e64 s[88:89], 26, v205
    v_cmp_le_i32_e64 s[90:91], 27, v205
    v_mov_b32 v3, 0xffff
    v_mov_b32 v4, 0xffff0000
    v_cndmask_b32_e64 v224, 0, v3, s[60:61]
    v_cndmask_b32_e64 v5, 0, v4, s[62:63]
    v_or_b32 v224, v224, v5
    v_cndmask_b32_e64 v225, 0, v3, s[64:65]
    v_cndmask_b32_e64 v5, 0, v4, s[66:67]
    v_or_b32 v225, v225, v5
    v_cndmask_b32_e64 v226, 0, v3, s[68:69]
    v_cndmask_b32_e64 v5, 0, v4, s[70:71]
    v_or_b32 v226, v226, v5
    v_cndmask_b32_e64 v227, 0, v3, s[72:73]
    v_cndmask_b32_e64 v5, 0, v4, s[74:75]
    v_or_b32 v227, v227, v5
    v_cndmask_b32_e64 v228, 0, v3, s[76:77]
    v_cndmask_b32_e64 v5, 0, v4, s[78:79]
    v_or_b32 v228, v228, v5
    v_cndmask_b32_e64 v229, 0, v3, s[80:81]
    v_cndmask_b32_e64 v5, 0, v4, s[82:83]
    v_or_b32 v229, v229, v5
    v_cndmask_b32_e64 v230, 0, v3, s[84:85]
    v_cndmask_b32_e64 v5, 0, v4, s[86:87]
    v_or_b32 v230, v230, v5
    v_cndmask_b32_e64 v231, 0, v3, s[88:89]
    v_cndmask_b32_e64 v5, 0, v4, s[90:91]
    v_or_b32 v231, v231, v5
    s_mov_b32 s92, 0x3e8b97f6
    s_mov_b32 s93, 0x3e8b97f6
    s_lshl_b32 s47, s20, 12
    s_add_u32 s47, s47, 114688
    v_add_u32 v200, s47, v2
    s_barrier
L_attn:
    ds_read_b128 v[168:171], v200 offset:32768
    ds_read_b128 v[172:175], v200 offset:33792
    ds_read_b128 v[176:179], v200 offset:0
    ds_read_b128 v[180:183], v200 offset:1024
    ds_read_b128 v[184:187], v200 offset:28672
    ds_read_b128 v[188:191], v200 offset:29696
    ds_read_b128 v[192:195], v200 offset:24576
    ds_read_b128 v[196:199], v200 offset:25600
    s_waitcnt lgkmcnt(4)
    v_mfma_f32_32x32x16_bf16 v[144:159], v[168:171], v[160:163], 0
    v_mfma_f32_32x32x16_bf16 v[16:31], v[176:179], v[160:163], 0
    v_mfma_f32_32x32x16_bf16 v[144:159], v[172:175], v[164:167], v[144:159]
    v_mfma_f32_32x32x16_bf16 v[16:31], v[180:183], v[164:167], v[16:31]
    ds_read_b128 v[168:171], v200 offset:20480
    ds_read_b128 v[172:175], v200 offset:21504
    ds_read_b128 v[176:179], v200 offset:16384
    ds_read_b128 v[180:183], v200 offset:17408
    s_waitcnt lgkmcnt(4)
    v_mfma_f32_32x32x16_bf16 v[128:143], v[184:187], v[160:163], 0
    v_mfma_f32_32x32x16_bf16 v[112:127], v[192:195], v[160:163], 0
    v_mfma_f32_32x32x16_bf16 v[128:143], v[188:191], v[164:167], v[128:143]
    v_mfma_f32_32x32x16_bf16 v[112:127], v[196:199], v[164:167], v[112:127]
    ds_read_b128 v[184:187], v200 offset:12288
    ds_read_b128 v[188:191], v200 offset:13312
    ds_read_b128 v[192:195], v200 offset:8192
    ds_read_b128 v[196:199], v200 offset:9216
    s_waitcnt lgkmcnt(4)
    v_mfma_f32_32x32x16_bf16 v[96:111], v[168:171], v[160:163], 0
    v_cndmask_b32_e64 v144, v16, v144, s[60:61]
    v_cndmask_b32_e64 v145, v17, v145, s[62:63]
    v_cndmask_b32_e64 v146, v18, v146, s[64:65]
    v_cndmask_b32_e64 v147, v19, v147, s[66:67]
    v_cndmask_b32_e64 v148, v20, v148, s[68:69]
    v_cndmask_b32_e64 v149, v21, v149, s[70:71]
    v_mfma_f32_32x32x16_bf16 v[80:95], v[176:179], v[160:163], 0
    v_cndmask_b32_e64 v150, v22, v150, s[72:73]
    v_cndmask_b32_e64 v151, v23, v151, s[74:75]
    v_cndmask_b32_e64 v152, v24, v152, s[76:77]
    v_cndmask_b32_e64 v153, v25, v153, s[78:79]
    v_cndmask_b32_e64 v154, v26, v154, s[80:81]
    v_cndmask_b32_e64 v155, v27, v155, s[82:83]
    v_mfma_f32_32x32x16_bf16 v[96:111], v[172:175], v[164:167], v[96:111]
    v_cndmask_b32_e64 v156, v28, v156, s[84:85]
    v_cndmask_b32_e64 v157, v29, v157, s[86:87]
    v_cndmask_b32_e64 v158, v30, v158, s[88:89]
    v_cndmask_b32_e64 v159, v31, v159, s[90:91]
    v_max3_f32 v201, v144, v145, v146
    v_max3_f32 v204, v147, v148, v149
    v_mfma_f32_32x32x16_bf16 v[80:95], v[180:183], v[164:167], v[80:95]
    v_max3_f32 v201, v201, v150, v151
    v_max3_f32 v204, v204, v152, v153
    v_max3_f32 v201, v201, v154, v155
    v_max3_f32 v204, v204, v156, v157
    v_max3_f32 v201, v201, v158, v159
    ds_read_b128 v[168:171], v200 offset:4096
    ds_read_b128 v[172:175], v200 offset:5120
    s_waitcnt lgkmcnt(2)
    v_mfma_f32_32x32x16_bf16 v[64:79], v[184:187], v[160:163], 0
    v_max3_f32 v201, v201, v128, v129
    v_max3_f32 v204, v204, v130, v131
    v_max3_f32 v201, v201, v132, v133
    v_max3_f32 v204, v204, v134, v135
    v_mfma_f32_32x32x16_bf16 v[48:63], v[192:195], v[160:163], 0
    v_max3_f32 v201, v201, v136, v137
    v_max3_f32 v204, v204, v138, v139
    v_max3_f32 v201, v201, v140, v141
    v_max3_f32 v204, v204, v142, v143
    v_mfma_f32_32x32x16_bf16 v[64:79], v[188:191], v[164:167], v[64:79]
    v_max3_f32 v201, v201, v112, v113
    v_max3_f32 v204, v204, v114, v115
    v_max3_f32 v201, v201, v116, v117
    v_max3_f32 v204, v204, v118, v119
    v_mfma_f32_32x32x16_bf16 v[48:63], v[196:199], v[164:167], v[48:63]
    v_max3_f32 v201, v201, v120, v121
    v_max3_f32 v204, v204, v122, v123
    v_max3_f32 v201, v201, v124, v125
    v_max3_f32 v204, v204, v126, v127
    s_waitcnt lgkmcnt(0)
    v_mfma_f32_32x32x16_bf16 v[32:47], v[168:171], v[160:163], 0
    v_max3_f32 v201, v201, v96, v97
    v_max3_f32 v204, v204, v98, v99
    v_max3_f32 v201, v201, v100, v101
    v_max3_f32 v204, v204, v102, v103
    v_max3_f32 v201, v201, v104, v105
    v_max3_f32 v204, v204, v106, v107
    v_max3_f32 v201, v201, v108, v109
    v_max3_f32 v204, v204, v110, v111
    v_mfma_f32_32x32x16_bf16 v[32:47], v[172:175], v[164:167], v[32:47]
    v_max3_f32 v201, v201, v80, v81
    v_max3_f32 v204, v204, v82, v83
    v_max3_f32 v201, v201, v84, v85
    v_max3_f32 v204, v204, v86, v87
    v_max3_f32 v201, v201, v88, v89
    v_max3_f32 v204, v204, v90, v91
    v_max3_f32 v201, v201, v92, v93
    v_max3_f32 v204, v204, v94, v95
    s_nop 7
    v_max3_f32 v201, v201, v64, v65
    v_max3_f32 v204, v204, v66, v67
    v_max3_f32 v201, v201, v68, v69
    v_max3_f32 v204, v204, v70, v71
    v_max3_f32 v201, v201, v72, v73
    v_max3_f32 v204, v204, v74, v75
    v_max3_f32 v201, v201, v76, v77
    v_max3_f32 v204, v204, v78, v79
    v_max3_f32 v201, v201, v48, v49
    v_max3_f32 v204, v204, v50, v51
    v_max3_f32 v201, v201, v52, v53
    v_max3_f32 v204, v204, v54, v55
    v_max3_f32 v201, v201, v56, v57
    v_max3_f32 v204, v204, v58, v59
    v_max3_f32 v201, v201, v60, v61
    v_max3_f32 v204, v204, v62, v63
    v_max3_f32 v201, v201, v32, v33
    v_max3_f32 v204, v204, v34, v35
    v_max3_f32 v201, v201, v36, v37
    v_max3_f32 v204, v204, v38, v39
    v_max3_f32 v201, v201, v40, v41
    v_max3_f32 v204, v204, v42, v43
    v_max3_f32 v201, v201, v44, v45
    v_max3_f32 v204, v204, v46, v47
    s_barrier
    ds_read_b128 v[168:171], v200 offset:34816
    ds_read_b128 v[172:175], v200 offset:35840
    ds_read_b128 v[176:179], v200 offset:2048
    ds_read_b128 v[180:183], v200 offset:3072
    v_max_f32 v202, v201, v204
    v_max_f32 v203, v201, v204
    s_nop 1
    v_permlane32_swap_b32 v202, v203
    s_nop 1
    v_max_f32 v201, v202, v203
    v_mul_f32 v202, 0xbe8b97f6, v201
    v_pk_fma_f32 v[144:145], v[144:145], s[92:93], v[202:203] op_sel_hi:[1,1,0]
    v_pk_fma_f32 v[146:147], v[146:147], s[92:93], v[202:203] op_sel_hi:[1,1,0]
    v_pk_fma_f32 v[148:149], v[148:149], s[92:93], v[202:203] op_sel_hi:[1,1,0]
    v_pk_fma_f32 v[150:151], v[150:151], s[92:93], v[202:203] op_sel_hi:[1,1,0]
    v_pk_fma_f32 v[152:153], v[152:153], s[92:93], v[202:203] op_sel_hi:[1,1,0]
    v_pk_fma_f32 v[154:155], v[154:155], s[92:93], v[202:203] op_sel_hi:[1,1,0]
    v_pk_fma_f32 v[156:157], v[156:157], s[92:93], v[202:203] op_sel_hi:[1,1,0]
    v_pk_fma_f32 v[158:159], v[158:159], s[92:93], v[202:203] op_sel_hi:[1,1,0]
    ds_read_b128 v[184:187], v200 offset:30720
    ds_read_b128 v[188:191], v200 offset:31744
    v_exp_f32 v144, v144
    v_exp_f32 v145, v145
    v_exp_f32 v146, v146
    v_exp_f32 v147, v147
    v_exp_f32 v148, v148
    v_exp_f32 v149, v149
    v_exp_f32 v150, v150
    v_exp_f32 v151, v151
    v_exp_f32 v152, v152
    v_exp_f32 v153, v153
    v_exp_f32 v154, v154
    v_exp_f32 v155, v155
    v_exp_f32 v156, v156
    v_exp_f32 v157, v157
    v_exp_f32 v158, v158
    v_exp_f32 v159, v159
    v_cvt_pk_bf16_f32 v144, v144, v145
    v_pk_fma_f32 v[128:129], v[128:129], s[92:93], v[202:203] op_sel_hi:[1,1,0]
    v_cvt_pk_bf16_f32 v145, v146, v147
    v_pk_fma_f32 v[130:131], v[130:131], s[92:93], v[202:203] op_sel_hi:[1,1,0]
    v_cvt_pk_bf16_f32 v146, v148, v149
    v_pk_fma_f32 v[132:133], v[132:133], s[92:93], v[202:203] op_sel_hi:[1,1,0]
    v_cvt_pk_bf16_f32 v147, v150, v151
    v_pk_fma_f32 v[134:135], v[134:135], s[92:93], v[202:203] op_sel_hi:[1,1,0]
    v_cvt_pk_bf16_f32 v148, v152, v153
    v_pk_fma_f32 v[136:137], v[136:137], s[92:93], v[202:203] op_sel_hi:[1,1,0]
    v_cvt_pk_bf16_f32 v149, v154, v155
    v_pk_fma_f32 v[138:139], v[138:139], s[92:93], v[202:203] op_sel_hi:[1,1,0]
    v_cvt_pk_bf16_f32 v150, v156, v157
    v_pk_fma_f32 v[140:141], v[140:141], s[92:93], v[202:203] op_sel_hi:[1,1,0]
    v_cvt_pk_bf16_f32 v151, v158, v159
    v_pk_fma_f32 v[142:143], v[142:143], s[92:93], v[202:203] op_sel_hi:[1,1,0]
    v_bfi_b32 v16, v224, 0, v144
    v_bfi_b32 v17, v225, 0, v145
    v_bfi_b32 v18, v226, 0, v146
    v_bfi_b32 v19, v227, 0, v147
    v_bfi_b32 v20, v228, 0, v148
    v_bfi_b32 v21, v229, 0, v149
    v_bfi_b32 v22, v230, 0, v150
    v_bfi_b32 v23, v231, 0, v151
    v_and_b32 v144, v224, v144
    v_and_b32 v145, v225, v145
    v_and_b32 v146, v226, v146
    v_and_b32 v147, v227, v147
    v_and_b32 v148, v228, v148
    v_and_b32 v149, v229, v149
    v_and_b32 v150, v230, v150
    v_and_b32 v151, v231, v151
    ds_read_b128 v[192:195], v200 offset:26624
    ds_read_b128 v[196:199], v200 offset:27648
    s_waitcnt lgkmcnt(4)
    v_mfma_f32_32x32x16_bf16 v[208:223], v[168:171], v[144:147], 0
    v_exp_f32 v128, v128
    v_exp_f32 v129, v129
    v_exp_f32 v130, v130
    v_exp_f32 v131, v131
    v_mfma_f32_32x32x16_bf16 v[208:223], v[172:175], v[148:151], v[208:223]
    v_exp_f32 v132, v132
    v_exp_f32 v133, v133
    v_exp_f32 v134, v134
    v_exp_f32 v135, v135
    v_mfma_f32_32x32x16_bf16 v[208:223], v[176:179], v[16:19], v[208:223]
    v_exp_f32 v136, v136
    v_exp_f32 v137, v137
    v_exp_f32 v138, v138
    v_exp_f32 v139, v139
    v_mfma_f32_32x32x16_bf16 v[208:223], v[180:183], v[20:23], v[208:223]
    v_exp_f32 v140, v140
    v_exp_f32 v141, v141
    v_exp_f32 v142, v142
    v_exp_f32 v143, v143
    v_cvt_pk_bf16_f32 v128, v128, v129
    v_pk_fma_f32 v[112:113], v[112:113], s[92:93], v[202:203] op_sel_hi:[1,1,0]
    v_cvt_pk_bf16_f32 v129, v130, v131
    v_pk_fma_f32 v[114:115], v[114:115], s[92:93], v[202:203] op_sel_hi:[1,1,0]
    v_cvt_pk_bf16_f32 v130, v132, v133
    v_pk_fma_f32 v[116:117], v[116:117], s[92:93], v[202:203] op_sel_hi:[1,1,0]
    v_cvt_pk_bf16_f32 v131, v134, v135
    v_pk_fma_f32 v[118:119], v[118:119], s[92:93], v[202:203] op_sel_hi:[1,1,0]
    v_cvt_pk_bf16_f32 v132, v136, v137
    v_pk_fma_f32 v[120:121], v[120:121], s[92:93], v[202:203] op_sel_hi:[1,1,0]
    v_cvt_pk_bf16_f32 v133, v138, v139
    v_pk_fma_f32 v[122:123], v[122:123], s[92:93], v[202:203] op_sel_hi:[1,1,0]
    v_cvt_pk_bf16_f32 v134, v140, v141
    v_pk_fma_f32 v[124:125], v[124:125], s[92:93], v[202:203] op_sel_hi:[1,1,0]
    v_cvt_pk_bf16_f32 v135, v142, v143
    v_pk_fma_f32 v[126:127], v[126:127], s[92:93], v[202:203] op_sel_hi:[1,1,0]
    s_waitcnt lgkmcnt(2)
    v_mfma_f32_32x32x16_bf16 v[208:223], v[184:187], v[128:131], v[208:223]
    v_exp_f32 v112, v112
    v_exp_f32 v113, v113
    v_exp_f32 v114, v114
    v_exp_f32 v115, v115
    v_exp_f32 v116, v116
    v_exp_f32 v117, v117
    v_exp_f32 v118, v118
    v_exp_f32 v119, v119
    v_mfma_f32_32x32x16_bf16 v[208:223], v[188:191], v[132:135], v[208:223]
    ds_read_b128 v[184:187], v200 offset:22528
    ds_read_b128 v[188:191], v200 offset:23552
    v_exp_f32 v120, v120
    v_exp_f32 v121, v121
    v_exp_f32 v122, v122
    v_exp_f32 v123, v123
    v_exp_f32 v124, v124
    v_exp_f32 v125, v125
    v_exp_f32 v126, v126
    v_exp_f32 v127, v127
    v_cvt_pk_bf16_f32 v112, v112, v113
    v_pk_fma_f32 v[96:97], v[96:97], s[92:93], v[202:203] op_sel_hi:[1,1,0]
    v_cvt_pk_bf16_f32 v113, v114, v115
    v_pk_fma_f32 v[98:99], v[98:99], s[92:93], v[202:203] op_sel_hi:[1,1,0]
    v_cvt_pk_bf16_f32 v114, v116, v117
    v_pk_fma_f32 v[100:101], v[100:101], s[92:93], v[202:203] op_sel_hi:[1,1,0]
    v_cvt_pk_bf16_f32 v115, v118, v119
    v_pk_fma_f32 v[102:103], v[102:103], s[92:93], v[202:203] op_sel_hi:[1,1,0]
    v_cvt_pk_bf16_f32 v116, v120, v121
    v_pk_fma_f32 v[104:105], v[104:105], s[92:93], v[202:203] op_sel_hi:[1,1,0]
    v_cvt_pk_bf16_f32 v117, v122, v123
    v_pk_fma_f32 v[106:107], v[106:107], s[92:93], v[202:203] op_sel_hi:[1,1,0]
    v_cvt_pk_bf16_f32 v118, v124, v125
    v_pk_fma_f32 v[108:109], v[108:109], s[92:93], v[202:203] op_sel_hi:[1,1,0]
    v_cvt_pk_bf16_f32 v119, v126, v127
    v_pk_fma_f32 v[110:111], v[110:111], s[92:93], v[202:203] op_sel_hi:[1,1,0]
    s_waitcnt lgkmcnt(2)
    v_mfma_f32_32x32x16_bf16 v[208:223], v[192:195], v[112:115], v[208:223]
    v_exp_f32 v96, v96
    v_exp_f32 v97, v97
    v_exp_f32 v98, v98
    v_exp_f32 v99, v99
    v_exp_f32 v100, v100
    v_exp_f32 v101, v101
    v_exp_f32 v102, v102
    v_exp_f32 v103, v103
    v_mfma_f32_32x32x16_bf16 v[208:223], v[196:199], v[116:119], v[208:223]
    ds_read_b128 v[192:195], v200 offset:18432
    ds_read_b128 v[196:199], v200 offset:19456
    v_exp_f32 v104, v104
    v_exp_f32 v105, v105
    v_exp_f32 v106, v106
    v_exp_f32 v107, v107
    v_exp_f32 v108, v108
    v_exp_f32 v109, v109
    v_exp_f32 v110, v110
    v_exp_f32 v111, v111
    v_cvt_pk_bf16_f32 v96, v96, v97
    v_pk_fma_f32 v[80:81], v[80:81], s[92:93], v[202:203] op_sel_hi:[1,1,0]
    v_cvt_pk_bf16_f32 v97, v98, v99
    v_pk_fma_f32 v[82:83], v[82:83], s[92:93], v[202:203] op_sel_hi:[1,1,0]
    v_cvt_pk_bf16_f32 v98, v100, v101
    v_pk_fma_f32 v[84:85], v[84:85], s[92:93], v[202:203] op_sel_hi:[1,1,0]
    v_cvt_pk_bf16_f32 v99, v102, v103
    v_pk_fma_f32 v[86:87], v[86:87], s[92:93], v[202:203] op_sel_hi:[1,1,0]
    v_cvt_pk_bf16_f32 v100, v104, v105
    v_pk_fma_f32 v[88:89], v[88:89], s[92:93], v[202:203] op_sel_hi:[1,1,0]
    v_cvt_pk_bf16_f32 v101, v106, v107
    v_pk_fma_f32 v[90:91], v[90:91], s[92:93], v[202:203] op_sel_hi:[1,1,0]
    v_cvt_pk_bf16_f32 v102, v108, v109
    v_pk_fma_f32 v[92:93], v[92:93], s[92:93], v[202:203] op_sel_hi:[1,1,0]
    v_cvt_pk_bf16_f32 v103, v110, v111
    v_pk_fma_f32 v[94:95], v[94:95], s[92:93], v[202:203] op_sel_hi:[1,1,0]
    s_waitcnt lgkmcnt(2)
    v_mfma_f32_32x32x16_bf16 v[208:223], v[184:187], v[96:99], v[208:223]
    v_exp_f32 v80, v80
    v_exp_f32 v81, v81
    v_exp_f32 v82, v82
    v_exp_f32 v83, v83
    v_exp_f32 v84, v84
    v_exp_f32 v85, v85
    v_exp_f32 v86, v86
    v_exp_f32 v87, v87
    v_mfma_f32_32x32x16_bf16 v[208:223], v[188:191], v[100:103], v[208:223]
    ds_read_b128 v[184:187], v200 offset:14336
    ds_read_b128 v[188:191], v200 offset:15360
    v_exp_f32 v88, v88
    v_exp_f32 v89, v89
    v_exp_f32 v90, v90
    v_exp_f32 v91, v91
    v_exp_f32 v92, v92
    v_exp_f32 v93, v93
    v_exp_f32 v94, v94
    v_exp_f32 v95, v95
    v_cvt_pk_bf16_f32 v80, v80, v81
    v_pk_fma_f32 v[64:65], v[64:65], s[92:93], v[202:203] op_sel_hi:[1,1,0]
    v_cvt_pk_bf16_f32 v81, v82, v83
    v_pk_fma_f32 v[66:67], v[66:67], s[92:93], v[202:203] op_sel_hi:[1,1,0]
    v_cvt_pk_bf16_f32 v82, v84, v85
    v_pk_fma_f32 v[68:69], v[68:69], s[92:93], v[202:203] op_sel_hi:[1,1,0]
    v_cvt_pk_bf16_f32 v83, v86, v87
    v_pk_fma_f32 v[70:71], v[70:71], s[92:93], v[202:203] op_sel_hi:[1,1,0]
    v_cvt_pk_bf16_f32 v84, v88, v89
    v_pk_fma_f32 v[72:73], v[72:73], s[92:93], v[202:203] op_sel_hi:[1,1,0]
    v_cvt_pk_bf16_f32 v85, v90, v91
    v_pk_fma_f32 v[74:75], v[74:75], s[92:93], v[202:203] op_sel_hi:[1,1,0]
    v_cvt_pk_bf16_f32 v86, v92, v93
    v_pk_fma_f32 v[76:77], v[76:77], s[92:93], v[202:203] op_sel_hi:[1,1,0]
    v_cvt_pk_bf16_f32 v87, v94, v95
    v_pk_fma_f32 v[78:79], v[78:79], s[92:93], v[202:203] op_sel_hi:[1,1,0]
    s_waitcnt lgkmcnt(2)
    v_mfma_f32_32x32x16_bf16 v[208:223], v[192:195], v[80:83], v[208:223]
    v_exp_f32 v64, v64
    v_exp_f32 v65, v65
    v_exp_f32 v66, v66
    v_exp_f32 v67, v67
    v_exp_f32 v68, v68
    v_exp_f32 v69, v69
    v_exp_f32 v70, v70
    v_exp_f32 v71, v71
    v_mfma_f32_32x32x16_bf16 v[208:223], v[196:199], v[84:87], v[208:223]
    ds_read_b128 v[192:195], v200 offset:10240
    ds_read_b128 v[196:199], v200 offset:11264
    v_exp_f32 v72, v72
    v_exp_f32 v73, v73
    v_exp_f32 v74, v74
    v_exp_f32 v75, v75
    v_exp_f32 v76, v76
    v_exp_f32 v77, v77
    v_exp_f32 v78, v78
    v_exp_f32 v79, v79
    v_cvt_pk_bf16_f32 v64, v64, v65
    v_pk_fma_f32 v[48:49], v[48:49], s[92:93], v[202:203] op_sel_hi:[1,1,0]
    v_cvt_pk_bf16_f32 v65, v66, v67
    v_pk_fma_f32 v[50:51], v[50:51], s[92:93], v[202:203] op_sel_hi:[1,1,0]
    v_cvt_pk_bf16_f32 v66, v68, v69
    v_pk_fma_f32 v[52:53], v[52:53], s[92:93], v[202:203] op_sel_hi:[1,1,0]
    v_cvt_pk_bf16_f32 v67, v70, v71
    v_pk_fma_f32 v[54:55], v[54:55], s[92:93], v[202:203] op_sel_hi:[1,1,0]
    v_cvt_pk_bf16_f32 v68, v72, v73
    v_pk_fma_f32 v[56:57], v[56:57], s[92:93], v[202:203] op_sel_hi:[1,1,0]
    v_cvt_pk_bf16_f32 v69, v74, v75
    v_pk_fma_f32 v[58:59], v[58:59], s[92:93], v[202:203] op_sel_hi:[1,1,0]
    v_cvt_pk_bf16_f32 v70, v76, v77
    v_pk_fma_f32 v[60:61], v[60:61], s[92:93], v[202:203] op_sel_hi:[1,1,0]
    v_cvt_pk_bf16_f32 v71, v78, v79
    v_pk_fma_f32 v[62:63], v[62:63], s[92:93], v[202:203] op_sel_hi:[1,1,0]
    s_waitcnt lgkmcnt(2)
    v_mfma_f32_32x32x16_bf16 v[208:223], v[184:187], v[64:67], v[208:223]
    v_exp_f32 v48, v48
    v_exp_f32 v49, v49
    v_exp_f32 v50, v50
    v_exp_f32 v51, v51
    v_exp_f32 v52, v52
    v_exp_f32 v53, v53
    v_exp_f32 v54, v54
    v_exp_f32 v55, v55
    v_mfma_f32_32x32x16_bf16 v[208:223], v[188:191], v[68:71], v[208:223]
    ds_read_b128 v[184:187], v200 offset:6144
    ds_read_b128 v[188:191], v200 offset:7168
    v_exp_f32 v56, v56
    v_exp_f32 v57, v57
    v_exp_f32 v58, v58
    v_exp_f32 v59, v59
    v_exp_f32 v60, v60
    v_exp_f32 v61, v61
    v_exp_f32 v62, v62
    v_exp_f32 v63, v63
    v_cvt_pk_bf16_f32 v48, v48, v49
    v_pk_fma_f32 v[32:33], v[32:33], s[92:93], v[202:203] op_sel_hi:[1,1,0]
    v_cvt_pk_bf16_f32 v49, v50, v51
    v_pk_fma_f32 v[34:35], v[34:35], s[92:93], v[202:203] op_sel_hi:[1,1,0]
    v_cvt_pk_bf16_f32 v50, v52, v53
    v_pk_fma_f32 v[36:37], v[36:37], s[92:93], v[202:203] op_sel_hi:[1,1,0]
    v_cvt_pk_bf16_f32 v51, v54, v55
    v_pk_fma_f32 v[38:39], v[38:39], s[92:93], v[202:203] op_sel_hi:[1,1,0]
    v_cvt_pk_bf16_f32 v52, v56, v57
    v_pk_fma_f32 v[40:41], v[40:41], s[92:93], v[202:203] op_sel_hi:[1,1,0]
    v_cvt_pk_bf16_f32 v53, v58, v59
    v_pk_fma_f32 v[42:43], v[42:43], s[92:93], v[202:203] op_sel_hi:[1,1,0]
    v_cvt_pk_bf16_f32 v54, v60, v61
    v_pk_fma_f32 v[44:45], v[44:45], s[92:93], v[202:203] op_sel_hi:[1,1,0]
    v_cvt_pk_bf16_f32 v55, v62, v63
    v_pk_fma_f32 v[46:47], v[46:47], s[92:93], v[202:203] op_sel_hi:[1,1,0]
    s_waitcnt lgkmcnt(2)
    v_mfma_f32_32x32x16_bf16 v[208:223], v[192:195], v[48:51], v[208:223]
    v_exp_f32 v32, v32
    v_exp_f32 v33, v33
    v_exp_f32 v34, v34
    v_exp_f32 v35, v35
    v_exp_f32 v36, v36
    v_exp_f32 v37, v37
    v_exp_f32 v38, v38
    v_exp_f32 v39, v39
    v_mfma_f32_32x32x16_bf16 v[208:223], v[196:199], v[52:55], v[208:223]
    v_exp_f32 v40, v40
    v_exp_f32 v41, v41
    v_exp_f32 v42, v42
    v_exp_f32 v43, v43
    v_exp_f32 v44, v44
    v_exp_f32 v45, v45
    v_exp_f32 v46, v46
    v_exp_f32 v47, v47
    v_cvt_pk_bf16_f32 v32, v32, v33
    v_cvt_pk_bf16_f32 v33, v34, v35
    v_cvt_pk_bf16_f32 v34, v36, v37
    v_cvt_pk_bf16_f32 v35, v38, v39
    v_cvt_pk_bf16_f32 v36, v40, v41
    v_cvt_pk_bf16_f32 v37, v42, v43
    v_cvt_pk_bf16_f32 v38, v44, v45
    v_cvt_pk_bf16_f32 v39, v46, v47
    s_waitcnt lgkmcnt(0)
    s_nop 0
    v_mfma_f32_32x32x16_bf16 v[208:223], v[184:187], v[32:35], v[208:223]
    v_mfma_f32_32x32x16_bf16 v[208:223], v[188:191], v[36:39], v[208:223]
    s_nop 7
    s_nop 3
L_attn_done:
    v_mov_b32 v202, v220
    v_mov_b32 v203, v220
    s_nop 1
    v_permlane32_swap_b32 v202, v203
    s_nop 1
    v_rcp_f32 v202, v203
    s_nop 0
    v_pk_mul_f32 v[208:209], v[208:209], v[202:203] op_sel_hi:[1,0]
    v_pk_mul_f32 v[210:211], v[210:211], v[202:203] op_sel_hi:[1,0]
    v_pk_mul_f32 v[212:213], v[212:213], v[202:203] op_sel_hi:[1,0]
    v_pk_mul_f32 v[214:215], v[214:215], v[202:203] op_sel_hi:[1,0]
    v_pk_mul_f32 v[216:217], v[216:217], v[202:203] op_sel_hi:[1,0]
    v_pk_mul_f32 v[218:219], v[218:219], v[202:203] op_sel_hi:[1,0]
    v_pk_mul_f32 v[220:221], v[220:221], v[202:203] op_sel_hi:[1,0]
    v_pk_mul_f32 v[222:223], v[222:223], v[202:203] op_sel_hi:[1,0]
    v_cvt_pk_bf16_f32 v208, v208, v209
    v_cvt_pk_bf16_f32 v209, v210, v211
    v_cvt_pk_bf16_f32 v210, v212, v213
    v_cvt_pk_bf16_f32 v211, v214, v215
    v_cvt_pk_bf16_f32 v212, v216, v217
    v_cvt_pk_bf16_f32 v213, v218, v219
    v_cvt_pk_bf16_f32 v214, v220, v221
    v_cvt_pk_bf16_f32 v215, v222, v223
    v_cndmask_b32_e64 v214, v214, 0, s[44:45]
    v_cndmask_b32_e64 v215, v215, 0, s[44:45]
    s_lshl_b32 s48, s23, 1
    s_xor_b32 s46, s21, 1
    s_add_u32 s48, s48, s46
    s_add_u32 s48, s48, 16
    s_lshl_b32 s46, s22, 2
    s_add_u32 s46, s46, s20
    s_lshl_b32 s46, s46, 5
    s_add_u32 s46, s46, s48
    s_lshl_b32 s46, s46, 11
    s_add_u32 s46, s46, 6307840
    buffer_store_dwordx4 v[208:211], v2, s[12:15], s46 offen offset:0 sc1
    buffer_store_dwordx4 v[212:215], v2, s[12:15], s46 offen offset:1024 sc1
    s_lshr_b32 s86, s24, 2
    s_lshl_b32 s46, s51, 1
    s_add_u32 s46, s46, s86
    s_lshl_b32 s89, s46, 7
    s_add_u32 s89, s89, 10571776
    s_mul_i32 s88, s46, 28672
    s_lshl_b32 s47, s52, 7
    s_add_u32 s88, s88, s47
    s_lshl_b32 s47, s20, 5
    s_add_u32 s88, s88, s47
    s_lshl_b32 s46, s46, 5
    s_lshl_b32 s47, s20, 3
    s_add_u32 s46, s46, s47
    s_lshl_b32 s46, s46, 11
    s_add_u32 s87, s46, 6307840
    s_mov_b32 s8, s40
    s_and_b32 s9, s41, 0xffff
    s_mov_b32 s10, 1835008
    s_mov_b32 s11, 0x20000
    v_bfe_u32 v142, v1, 2, 2
    v_lshrrev_b32 v147, 5, v1
    v_lshl_add_u32 v143, v147, 2, v142
    v_lshlrev_b32 v143, 7, v143
    s_mul_i32 s47, s20, 28672
    v_add_u32 v143, s47, v143
    v_and_b32 v144, 1, v1
    v_lshl_add_u32 v143, v144, 3, v143
    v_bfe_u32 v144, v1, 4, 1
    v_lshlrev_b32 v144, 1, v144
    v_bfe_u32 v145, v1, 1, 1
    v_or_b32 v144, v144, v145
    v_lshrrev_b32 v145, 1, v142
    v_lshlrev_b32 v145, 2, v145
    v_or_b32 v146, v144, v145
    v_lshl_add_u32 v128, v146, 4, v143
    v_xor_b32 v145, 4, v145
    v_or_b32 v146, v144, v145
    v_lshl_add_u32 v129, v146, 4, v143
    v_lshlrev_b32 v147, 9, v147
    v_sub_u32 v130, v128, v147
    v_sub_u32 v131, v129, v147
    s_mul_i32 s46, s86, 24576
    s_add_u32 s46, s46, 114688
    v_add_u32 v132, s46, v2
    s_mul_i32 s47, s20, 6144
    v_add_u32 v133, s47, v132
    v_and_b32 v142, 31, v1
    v_lshlrev_b32 v136, 2, v142
    v_mul_u32_u24 v134, 896, v142
    v_lshrrev_b32 v143, 5, v1
    v_lshl_add_u32 v134, v143, 4, v134
    s_waitcnt vmcnt(0)
    s_lshl_b32 s47, s21, 2
    s_sub_u32 s47, 7, s47
    v_mov_b32 v3, 163808
    v_mov_b32 v4, 1
    s_mov_b64 exec, 1
    ds_add_rtn_u32 v4, v3, v4
    s_mov_b64 exec, -1
    s_waitcnt lgkmcnt(0)
    v_readfirstlane_b32 s46, v4
    s_cmp_lg_u32 s46, s47
    s_cbranch_scc1 L_notlast_47
    s_cmp_lg_u32 s53, 0
    s_cbranch_scc1 L_nok_48
    s_mov_b32 s59, 262144
    v_mov_b32 v4, 0
L_npoll_49:
    buffer_load_dword v3, v4, s[96:99], 0 offen sc1
    s_waitcnt vmcnt(0)
    v_readfirstlane_b32 s53, v3
    s_sub_u32 s59, s59, 1
    s_cbranch_scc1 L_nok_48
    s_cmp_eq_u32 s53, 0
    s_cbranch_scc1 L_npoll_49
L_nok_48:
    s_mul_i32 s46, s22, 16
    s_add_u32 s46, s46, s50
    s_lshl_b32 s46, s46, 7
    s_add_u32 s46, s46, 10649600
    v_mov_b32 v3, s53
    v_mov_b32 v4, 0
    s_mov_b64 exec, 1
    buffer_store_dword v3, v4, s[12:15], s46 offen sc1
    s_mov_b64 exec, -1
L_notlast_47:
    s_cmp_eq_u32 s52, 7
    s_cbranch_scc1 L_fin
    s_barrier
L_final:
    s_mov_b32 s46, s87
    buffer_load_dwordx4 v[48:51], v2, s[12:15], s46 offen offset:0
    buffer_load_dwordx4 v[52:55], v2, s[12:15], s46 offen offset:1024
    s_add_u32 s46, s46, 2048
    buffer_load_dwordx4 v[56:59], v2, s[12:15], s46 offen offset:0
    buffer_load_dwordx4 v[60:63], v2, s[12:15], s46 offen offset:1024
    s_add_u32 s46, s46, 2048
    buffer_load_dwordx4 v[64:67], v2, s[12:15], s46 offen offset:0
    buffer_load_dwordx4 v[68:71], v2, s[12:15], s46 offen offset:1024
    s_add_u32 s46, s46, 2048
    buffer_load_dwordx4 v[72:75], v2, s[12:15], s46 offen offset:0
    buffer_load_dwordx4 v[76:79], v2, s[12:15], s46 offen offset:1024
    s_add_u32 s46, s46, 2048
    buffer_load_dwordx4 v[80:83], v2, s[12:15], s46 offen offset:0
    buffer_load_dwordx4 v[84:87], v2, s[12:15], s46 offen offset:1024
    s_add_u32 s46, s46, 2048
    buffer_load_dwordx4 v[88:91], v2, s[12:15], s46 offen offset:0
    buffer_load_dwordx4 v[92:95], v2, s[12:15], s46 offen offset:1024
    s_add_u32 s46, s46, 2048
    buffer_load_dwordx4 v[96:99], v2, s[12:15], s46 offen offset:0
    buffer_load_dwordx4 v[100:103], v2, s[12:15], s46 offen offset:1024
    s_add_u32 s46, s46, 2048
    buffer_load_dwordx4 v[104:107], v2, s[12:15], s46 offen offset:0
    buffer_load_dwordx4 v[108:111], v2, s[12:15], s46 offen offset:1024
    buffer_load_dword v141, v136, s[12:15], s89 offen
    ds_read_b64_tr_b16 v[112:113], v128 offset:0
    ds_read_b64_tr_b16 v[114:115], v128 offset:1024
    ds_read_b64_tr_b16 v[116:117], v129 offset:0
    ds_read_b64_tr_b16 v[118:119], v129 offset:1024
    ds_read_b64_tr_b16 v[120:121], v128 offset:2048
    ds_read_b64_tr_b16 v[122:123], v128 offset:3072
    ds_read_b64_tr_b16 v[124:125], v129 offset:2048
    ds_read_b64_tr_b16 v[126:127], v129 offset:3072
    s_waitcnt vmcnt(16) lgkmcnt(4)
    v_mfma_f32_32x32x16_bf16 v[16:31], v[112:115], v[48:51], 0
    v_mfma_f32_32x32x16_bf16 v[32:47], v[116:119], v[48:51], 0
    ds_read_b64_tr_b16 v[112:113], v128 offset:3584
    ds_read_b64_tr_b16 v[114:115], v128 offset:4608
    ds_read_b64_tr_b16 v[116:117], v129 offset:3584
    ds_read_b64_tr_b16 v[118:119], v129 offset:4608
    s_waitcnt vmcnt(15) lgkmcnt(4)
    v_mfma_f32_32x32x16_bf16 v[16:31], v[120:123], v[52:55], v[16:31]
    v_mfma_f32_32x32x16_bf16 v[32:47], v[124:127], v[52:55], v[32:47]
    ds_read_b64_tr_b16 v[120:121], v128 offset:5632
    ds_read_b64_tr_b16 v[122:123], v128 offset:6656
    ds_read_b64_tr_b16 v[124:125], v129 offset:5632
    ds_read_b64_tr_b16 v[126:127], v129 offset:6656
    s_waitcnt vmcnt(14) lgkmcnt(4)
    v_mfma_f32_32x32x16_bf16 v[16:31], v[112:115], v[56:59], v[16:31]
    v_mfma_f32_32x32x16_bf16 v[32:47], v[116:119], v[56:59], v[32:47]
    ds_read_b64_tr_b16 v[112:113], v128 offset:7168
    ds_read_b64_tr_b16 v[114:115], v128 offset:8192
    ds_read_b64_tr_b16 v[116:117], v129 offset:7168
    ds_read_b64_tr_b16 v[118:119], v129 offset:8192
    s_waitcnt vmcnt(13) lgkmcnt(4)
    v_mfma_f32_32x32x16_bf16 v[16:31], v[120:123], v[60:63], v[16:31]
    v_mfma_f32_32x32x16_bf16 v[32:47], v[124:127], v[60:63], v[32:47]
    ds_read_b64_tr_b16 v[120:121], v128 offset:9216
    ds_read_b64_tr_b16 v[122:123], v128 offset:10240
    ds_read_b64_tr_b16 v[124:125], v129 offset:9216
    ds_read_b64_tr_b16 v[126:127], v129 offset:10240
    s_waitcnt vmcnt(12) lgkmcnt(4)
    v_mfma_f32_32x32x16_bf16 v[16:31], v[112:115], v[64:67], v[16:31]
    v_mfma_f32_32x32x16_bf16 v[32:47], v[116:119], v[64:67], v[32:47]
    ds_read_b64_tr_b16 v[112:113], v128 offset:10752
    ds_read_b64_tr_b16 v[114:115], v128 offset:11776
    ds_read_b64_tr_b16 v[116:117], v129 offset:10752
    ds_read_b64_tr_b16 v[118:119], v129 offset:11776
    s_waitcnt vmcnt(11) lgkmcnt(4)
    v_mfma_f32_32x32x16_bf16 v[16:31], v[120:123], v[68:71], v[16:31]
    v_mfma_f32_32x32x16_bf16 v[32:47], v[124:127], v[68:71], v[32:47]
    ds_read_b64_tr_b16 v[120:121], v128 offset:12800
    ds_read_b64_tr_b16 v[122:123], v128 offset:13824
    ds_read_b64_tr_b16 v[124:125], v129 offset:12800
    ds_read_b64_tr_b16 v[126:127], v129 offset:13824
    s_waitcnt vmcnt(10) lgkmcnt(4)
    v_mfma_f32_32x32x16_bf16 v[16:31], v[112:115], v[72:75], v[16:31]
    v_mfma_f32_32x32x16_bf16 v[32:47], v[116:119], v[72:75], v[32:47]
    ds_read_b64_tr_b16 v[112:113], v128 offset:14336
    ds_read_b64_tr_b16 v[114:115], v128 offset:15360
    ds_read_b64_tr_b16 v[116:117], v129 offset:14336
    ds_read_b64_tr_b16 v[118:119], v129 offset:15360
    s_waitcnt vmcnt(9) lgkmcnt(4)
    v_mfma_f32_32x32x16_bf16 v[16:31], v[120:123], v[76:79], v[16:31]
    v_mfma_f32_32x32x16_bf16 v[32:47], v[124:127], v[76:79], v[32:47]
    ds_read_b64_tr_b16 v[120:121], v128 offset:16384
    ds_read_b64_tr_b16 v[122:123], v128 offset:17408
    ds_read_b64_tr_b16 v[124:125], v129 offset:16384
    ds_read_b64_tr_b16 v[126:127], v129 offset:17408
    s_waitcnt vmcnt(8) lgkmcnt(4)
    v_mfma_f32_32x32x16_bf16 v[16:31], v[112:115], v[80:83], v[16:31]
    v_mfma_f32_32x32x16_bf16 v[32:47], v[116:119], v[80:83], v[32:47]
    ds_read_b64_tr_b16 v[112:113], v128 offset:17920
    ds_read_b64_tr_b16 v[114:115], v128 offset:18944
    ds_read_b64_tr_b16 v[116:117], v129 offset:17920
    ds_read_b64_tr_b16 v[118:119], v129 offset:18944
    s_waitcnt vmcnt(7) lgkmcnt(4)
    v_mfma_f32_32x32x16_bf16 v[16:31], v[120:123], v[84:87], v[16:31]
    v_mfma_f32_32x32x16_bf16 v[32:47], v[124:127], v[84:87], v[32:47]
    ds_read_b64_tr_b16 v[120:121], v128 offset:19968
    ds_read_b64_tr_b16 v[122:123], v128 offset:20992
    ds_read_b64_tr_b16 v[124:125], v129 offset:19968
    ds_read_b64_tr_b16 v[126:127], v129 offset:20992
    s_waitcnt vmcnt(6) lgkmcnt(4)
    v_mfma_f32_32x32x16_bf16 v[16:31], v[112:115], v[88:91], v[16:31]
    v_mfma_f32_32x32x16_bf16 v[32:47], v[116:119], v[88:91], v[32:47]
    ds_read_b64_tr_b16 v[112:113], v128 offset:21504
    ds_read_b64_tr_b16 v[114:115], v128 offset:22528
    ds_read_b64_tr_b16 v[116:117], v129 offset:21504
    ds_read_b64_tr_b16 v[118:119], v129 offset:22528
    s_waitcnt vmcnt(5) lgkmcnt(4)
    v_mfma_f32_32x32x16_bf16 v[16:31], v[120:123], v[92:95], v[16:31]
    v_mfma_f32_32x32x16_bf16 v[32:47], v[124:127], v[92:95], v[32:47]
    ds_read_b64_tr_b16 v[120:121], v128 offset:23552
    ds_read_b64_tr_b16 v[122:123], v128 offset:24576
    ds_read_b64_tr_b16 v[124:125], v129 offset:23552
    ds_read_b64_tr_b16 v[126:127], v129 offset:24576
    s_waitcnt vmcnt(4) lgkmcnt(4)
    v_mfma_f32_32x32x16_bf16 v[16:31], v[112:115], v[96:99], v[16:31]
    v_mfma_f32_32x32x16_bf16 v[32:47], v[116:119], v[96:99], v[32:47]
    ds_read_b64_tr_b16 v[112:113], v128 offset:25088
    ds_read_b64_tr_b16 v[114:115], v128 offset:26112
    ds_read_b64_tr_b16 v[116:117], v129 offset:25088
    ds_read_b64_tr_b16 v[118:119], v129 offset:26112
    s_waitcnt vmcnt(3) lgkmcnt(4)
    v_mfma_f32_32x32x16_bf16 v[16:31], v[120:123], v[100:103], v[16:31]
    v_mfma_f32_32x32x16_bf16 v[32:47], v[124:127], v[100:103], v[32:47]
    ds_read_b64_tr_b16 v[120:121], v128 offset:27136
    ds_read_b64_tr_b16 v[122:123], v130 offset:28160
    ds_read_b64_tr_b16 v[124:125], v129 offset:27136
    ds_read_b64_tr_b16 v[126:127], v131 offset:28160
    s_waitcnt vmcnt(2) lgkmcnt(4)
    v_mfma_f32_32x32x16_bf16 v[16:31], v[112:115], v[104:107], v[16:31]
    v_mfma_f32_32x32x16_bf16 v[32:47], v[116:119], v[104:107], v[32:47]
    s_waitcnt vmcnt(0) lgkmcnt(0)
    v_mfma_f32_32x32x16_bf16 v[16:31], v[120:123], v[108:111], v[16:31]
    v_mfma_f32_32x32x16_bf16 v[32:47], v[124:127], v[108:111], v[32:47]
    v_sub_f32 v140, 1.0, v141
    s_cmp_eq_u32 s20, 1
    s_cbranch_scc1 L_red1_51
    s_cmp_eq_u32 s20, 2
    s_cbranch_scc1 L_red2_52
    s_cmp_eq_u32 s20, 3
    s_cbranch_scc1 L_red3_53
L_red0_50:
    s_nop 7
    s_nop 2
    ds_write_b128 v132, v[24:27] offset:10240
    ds_write_b128 v132, v[28:31] offset:11264
    ds_write_b128 v132, v[32:35] offset:14336
    ds_write_b128 v132, v[36:39] offset:15360
    ds_write_b128 v132, v[40:43] offset:18432
    ds_write_b128 v132, v[44:47] offset:19456
    s_waitcnt lgkmcnt(0)
    s_barrier
    ds_read_b128 v[168:171], v133 offset:0
    ds_read_b128 v[172:175], v133 offset:1024
    ds_read_b128 v[176:179], v133 offset:2048
    ds_read_b128 v[180:183], v133 offset:3072
    ds_read_b128 v[184:187], v133 offset:4096
    ds_read_b128 v[188:191], v133 offset:5120
    s_waitcnt lgkmcnt(0)
    v_pk_add_f32 v[160:161], v[16:17], v[168:169]
    v_pk_add_f32 v[48:49], v[176:177], v[184:185]
    v_pk_add_f32 v[162:163], v[18:19], v[170:171]
    v_pk_add_f32 v[50:51], v[178:179], v[186:187]
    v_pk_add_f32 v[164:165], v[20:21], v[172:173]
    v_pk_add_f32 v[52:53], v[180:181], v[188:189]
    v_pk_add_f32 v[166:167], v[22:23], v[174:175]
    v_pk_add_f32 v[54:55], v[182:183], v[190:191]
    v_pk_mul_f32 v[160:161], v[160:161], v[140:141] op_sel:[0,1] op_sel_hi:[1,1]
    v_pk_mul_f32 v[162:163], v[162:163], v[140:141] op_sel:[0,1] op_sel_hi:[1,1]
    v_pk_mul_f32 v[164:165], v[164:165], v[140:141] op_sel:[0,1] op_sel_hi:[1,1]
    v_pk_mul_f32 v[166:167], v[166:167], v[140:141] op_sel:[0,1] op_sel_hi:[1,1]
    v_pk_fma_f32 v[160:161], v[48:49], v[140:141], v[160:161] op_sel:[0,0,0] op_sel_hi:[1,0,1]
    v_pk_fma_f32 v[162:163], v[50:51], v[140:141], v[162:163] op_sel:[0,0,0] op_sel_hi:[1,0,1]
    v_pk_fma_f32 v[164:165], v[52:53], v[140:141], v[164:165] op_sel:[0,0,0] op_sel_hi:[1,0,1]
    v_pk_fma_f32 v[166:167], v[54:55], v[140:141], v[166:167] op_sel:[0,0,0] op_sel_hi:[1,0,1]
    s_branch L_redj_54
L_red1_51:
    s_nop 7
    s_nop 2
    ds_write_b128 v132, v[32:35] offset:16384
    ds_write_b128 v132, v[36:39] offset:17408
    ds_write_b128 v132, v[40:43] offset:20480
    ds_write_b128 v132, v[44:47] offset:21504
    ds_write_b128 v132, v[16:19] offset:0
    ds_write_b128 v132, v[20:23] offset:1024
    s_waitcnt lgkmcnt(0)
    s_barrier
    ds_read_b128 v[168:171], v133 offset:0
    ds_read_b128 v[172:175], v133 offset:1024
    ds_read_b128 v[176:179], v133 offset:2048
    ds_read_b128 v[180:183], v133 offset:3072
    ds_read_b128 v[184:187], v133 offset:4096
    ds_read_b128 v[188:191], v133 offset:5120
    s_waitcnt lgkmcnt(0)
    v_pk_add_f32 v[160:161], v[184:185], v[24:25]
    v_pk_add_f32 v[48:49], v[168:169], v[176:177]
    v_pk_add_f32 v[162:163], v[186:187], v[26:27]
    v_pk_add_f32 v[50:51], v[170:171], v[178:179]
    v_pk_add_f32 v[164:165], v[188:189], v[28:29]
    v_pk_add_f32 v[52:53], v[172:173], v[180:181]
    v_pk_add_f32 v[166:167], v[190:191], v[30:31]
    v_pk_add_f32 v[54:55], v[174:175], v[182:183]
    v_pk_mul_f32 v[160:161], v[160:161], v[140:141] op_sel:[0,1] op_sel_hi:[1,1]
    v_pk_mul_f32 v[162:163], v[162:163], v[140:141] op_sel:[0,1] op_sel_hi:[1,1]
    v_pk_mul_f32 v[164:165], v[164:165], v[140:141] op_sel:[0,1] op_sel_hi:[1,1]
    v_pk_mul_f32 v[166:167], v[166:167], v[140:141] op_sel:[0,1] op_sel_hi:[1,1]
    v_pk_fma_f32 v[160:161], v[48:49], v[140:141], v[160:161] op_sel:[0,0,0] op_sel_hi:[1,0,1]
    v_pk_fma_f32 v[162:163], v[50:51], v[140:141], v[162:163] op_sel:[0,0,0] op_sel_hi:[1,0,1]
    v_pk_fma_f32 v[164:165], v[52:53], v[140:141], v[164:165] op_sel:[0,0,0] op_sel_hi:[1,0,1]
    v_pk_fma_f32 v[166:167], v[54:55], v[140:141], v[166:167] op_sel:[0,0,0] op_sel_hi:[1,0,1]
    s_branch L_redj_54
L_red2_52:
    s_nop 7
    s_nop 2
    ds_write_b128 v132, v[40:43] offset:22528
    ds_write_b128 v132, v[44:47] offset:23552
    ds_write_b128 v132, v[16:19] offset:2048
    ds_write_b128 v132, v[20:23] offset:3072
    ds_write_b128 v132, v[24:27] offset:6144
    ds_write_b128 v132, v[28:31] offset:7168
    s_waitcnt lgkmcnt(0)
    s_barrier
    ds_read_b128 v[168:171], v133 offset:0
    ds_read_b128 v[172:175], v133 offset:1024
    ds_read_b128 v[176:179], v133 offset:2048
    ds_read_b128 v[180:183], v133 offset:3072
    ds_read_b128 v[184:187], v133 offset:4096
    ds_read_b128 v[188:191], v133 offset:5120
    s_waitcnt lgkmcnt(0)
    v_pk_add_f32 v[160:161], v[176:177], v[184:185]
    v_pk_add_f32 v[48:49], v[32:33], v[168:169]
    v_pk_add_f32 v[162:163], v[178:179], v[186:187]
    v_pk_add_f32 v[50:51], v[34:35], v[170:171]
    v_pk_add_f32 v[164:165], v[180:181], v[188:189]
    v_pk_add_f32 v[52:53], v[36:37], v[172:173]
    v_pk_add_f32 v[166:167], v[182:183], v[190:191]
    v_pk_add_f32 v[54:55], v[38:39], v[174:175]
    v_pk_mul_f32 v[160:161], v[160:161], v[140:141] op_sel:[0,1] op_sel_hi:[1,1]
    v_pk_mul_f32 v[162:163], v[162:163], v[140:141] op_sel:[0,1] op_sel_hi:[1,1]
    v_pk_mul_f32 v[164:165], v[164:165], v[140:141] op_sel:[0,1] op_sel_hi:[1,1]
    v_pk_mul_f32 v[166:167], v[166:167], v[140:141] op_sel:[0,1] op_sel_hi:[1,1]
    v_pk_fma_f32 v[160:161], v[48:49], v[140:141], v[160:161] op_sel:[0,0,0] op_sel_hi:[1,0,1]
    v_pk_fma_f32 v[162:163], v[50:51], v[140:141], v[162:163] op_sel:[0,0,0] op_sel_hi:[1,0,1]
    v_pk_fma_f32 v[164:165], v[52:53], v[140:141], v[164:165] op_sel:[0,0,0] op_sel_hi:[1,0,1]
    v_pk_fma_f32 v[166:167], v[54:55], v[140:141], v[166:167] op_sel:[0,0,0] op_sel_hi:[1,0,1]
    s_branch L_redj_54
L_red3_53:
    s_nop 7
    s_nop 2
    ds_write_b128 v132, v[16:19] offset:4096
    ds_write_b128 v132, v[20:23] offset:5120
    ds_write_b128 v132, v[24:27] offset:8192
    ds_write_b128 v132, v[28:31] offset:9216
    ds_write_b128 v132, v[32:35] offset:12288
    ds_write_b128 v132, v[36:39] offset:13312
    s_waitcnt lgkmcnt(0)
    s_barrier
    ds_read_b128 v[168:171], v133 offset:0
    ds_read_b128 v[172:175], v133 offset:1024
    ds_read_b128 v[176:179], v133 offset:2048
    ds_read_b128 v[180:183], v133 offset:3072
    ds_read_b128 v[184:187], v133 offset:4096
    ds_read_b128 v[188:191], v133 offset:5120
    s_waitcnt lgkmcnt(0)
    v_pk_add_f32 v[160:161], v[168:169], v[176:177]
    v_pk_add_f32 v[48:49], v[184:185], v[40:41]
    v_pk_add_f32 v[162:163], v[170:171], v[178:179]
    v_pk_add_f32 v[50:51], v[186:187], v[42:43]
    v_pk_add_f32 v[164:165], v[172:173], v[180:181]
    v_pk_add_f32 v[52:53], v[188:189], v[44:45]
    v_pk_add_f32 v[166:167], v[174:175], v[182:183]
    v_pk_add_f32 v[54:55], v[190:191], v[46:47]
    v_pk_mul_f32 v[160:161], v[160:161], v[140:141] op_sel:[0,1] op_sel_hi:[1,1]
    v_pk_mul_f32 v[162:163], v[162:163], v[140:141] op_sel:[0,1] op_sel_hi:[1,1]
    v_pk_mul_f32 v[164:165], v[164:165], v[140:141] op_sel:[0,1] op_sel_hi:[1,1]
    v_pk_mul_f32 v[166:167], v[166:167], v[140:141] op_sel:[0,1] op_sel_hi:[1,1]
    v_pk_fma_f32 v[160:161], v[48:49], v[140:141], v[160:161] op_sel:[0,0,0] op_sel_hi:[1,0,1]
    v_pk_fma_f32 v[162:163], v[50:51], v[140:141], v[162:163] op_sel:[0,0,0] op_sel_hi:[1,0,1]
    v_pk_fma_f32 v[164:165], v[52:53], v[140:141], v[164:165] op_sel:[0,0,0] op_sel_hi:[1,0,1]
    v_pk_fma_f32 v[166:167], v[54:55], v[140:141], v[166:167] op_sel:[0,0,0] op_sel_hi:[1,0,1]
L_redj_54:
    v_cvt_pk_bf16_f32 v160, v160, v161
    v_cvt_pk_bf16_f32 v161, v162, v163
    v_cvt_pk_bf16_f32 v162, v164, v165
    v_cvt_pk_bf16_f32 v163, v166, v167
    s_nop 1
    v_permlane32_swap_b32 v160, v162
    v_permlane32_swap_b32 v161, v163
    buffer_store_dwordx4 v[160:163], v134, s[8:11], s88 offen
L_fin:
L_end:
    s_endpgm
L_lin:
    ds_read_b128 v[112:115], v244 offset:0
    ds_read_b64_tr_b16 v[80:81], v248 offset:0
    ds_read_b64_tr_b16 v[82:83], v248 offset:112
    ds_read_b64_tr_b16 v[84:85], v248 offset:56
    ds_read_b64_tr_b16 v[86:87], v248 offset:168
    ds_read_b64_tr_b16 v[88:89], v248 offset:7168
    ds_read_b64_tr_b16 v[90:91], v248 offset:7280
    ds_read_b64_tr_b16 v[92:93], v248 offset:7224
    ds_read_b64_tr_b16 v[94:95], v248 offset:7336
    ds_read_b128 v[116:119], v245 offset:0
    ds_read_b64_tr_b16 v[96:97], v248 offset:1792
    ds_read_b64_tr_b16 v[98:99], v248 offset:1904
    s_waitcnt lgkmcnt(9)
    v_mfma_f32_32x32x16_bf16 v[16:31], v[112:115], v[80:83], 0
    ds_read_b64_tr_b16 v[100:101], v248 offset:1848
    ds_read_b64_tr_b16 v[102:103], v248 offset:1960
    ds_read_b64_tr_b16 v[104:105], v248 offset:8960
    ds_read_b64_tr_b16 v[106:107], v248 offset:9072
    s_waitcnt lgkmcnt(11)
    v_mfma_f32_32x32x16_bf16 v[32:47], v[112:115], v[84:87], 0
    ds_read_b64_tr_b16 v[108:109], v248 offset:9016
    ds_read_b64_tr_b16 v[110:111], v248 offset:9128
    s_waitcnt lgkmcnt(11)
    v_mfma_f32_32x32x16_bf16 v[48:63], v[112:115], v[88:91], 0
    s_waitcnt lgkmcnt(9)
    v_mfma_f32_32x32x16_bf16 v[64:79], v[112:115], v[92:95], 0
    ds_read_b128 v[120:123], v246 offset:0
    ds_read_b64_tr_b16 v[80:81], v248 offset:3584
    ds_read_b64_tr_b16 v[82:83], v248 offset:3696
    s_waitcnt lgkmcnt(9)
    v_mfma_f32_32x32x16_bf16 v[16:31], v[116:119], v[96:99], v[16:31]
    ds_read_b64_tr_b16 v[84:85], v248 offset:3640
    ds_read_b64_tr_b16 v[86:87], v248 offset:3752
    ds_read_b64_tr_b16 v[88:89], v248 offset:10752
    ds_read_b64_tr_b16 v[90:91], v248 offset:10864
    s_waitcnt lgkmcnt(11)
    v_mfma_f32_32x32x16_bf16 v[32:47], v[116:119], v[100:103], v[32:47]
    ds_read_b64_tr_b16 v[92:93], v248 offset:10808
    ds_read_b64_tr_b16 v[94:95], v248 offset:10920
    s_waitcnt lgkmcnt(11)
    v_mfma_f32_32x32x16_bf16 v[48:63], v[116:119], v[104:107], v[48:63]
    s_waitcnt lgkmcnt(9)
    v_mfma_f32_32x32x16_bf16 v[64:79], v[116:119], v[108:111], v[64:79]
    ds_read_b128 v[124:127], v247 offset:0
    ds_read_b64_tr_b16 v[96:97], v248 offset:5376
    ds_read_b64_tr_b16 v[98:99], v248 offset:5488
    s_waitcnt lgkmcnt(9)
    v_mfma_f32_32x32x16_bf16 v[16:31], v[120:123], v[80:83], v[16:31]
    ds_read_b64_tr_b16 v[100:101], v248 offset:5432
    ds_read_b64_tr_b16 v[102:103], v248 offset:5544
    ds_read_b64_tr_b16 v[104:105], v248 offset:12544
    ds_read_b64_tr_b16 v[106:107], v248 offset:12656
    s_waitcnt lgkmcnt(11)
    v_mfma_f32_32x32x16_bf16 v[32:47], v[120:123], v[84:87], v[32:47]
    ds_read_b64_tr_b16 v[108:109], v248 offset:12600
    ds_read_b64_tr_b16 v[110:111], v248 offset:12712
    s_waitcnt lgkmcnt(11)
    v_mfma_f32_32x32x16_bf16 v[48:63], v[120:123], v[88:91], v[48:63]
    s_waitcnt lgkmcnt(9)
    v_mfma_f32_32x32x16_bf16 v[64:79], v[120:123], v[92:95], v[64:79]
    s_barrier
    ds_read_b128 v[128:131], v244 offset:16384
    ds_read_b64_tr_b16 v[80:81], v248 offset:14336
    ds_read_b64_tr_b16 v[82:83], v248 offset:14448
    s_waitcnt lgkmcnt(9)
    v_mfma_f32_32x32x16_bf16 v[16:31], v[124:127], v[96:99], v[16:31]
    ds_read_b64_tr_b16 v[84:85], v248 offset:14392
    ds_read_b64_tr_b16 v[86:87], v248 offset:14504
    ds_read_b64_tr_b16 v[88:89], v248 offset:21504
    ds_read_b64_tr_b16 v[90:91], v248 offset:21616
    s_waitcnt lgkmcnt(11)
    v_mfma_f32_32x32x16_bf16 v[32:47], v[124:127], v[100:103], v[32:47]
    ds_read_b64_tr_b16 v[92:93], v248 offset:21560
    ds_read_b64_tr_b16 v[94:95], v248 offset:21672
    s_waitcnt lgkmcnt(11)
    v_mfma_f32_32x32x16_bf16 v[48:63], v[124:127], v[104:107], v[48:63]
    s_waitcnt lgkmcnt(9)
    v_mfma_f32_32x32x16_bf16 v[64:79], v[124:127], v[108:111], v[64:79]
    ds_read_b128 v[132:135], v245 offset:16384
    ds_read_b64_tr_b16 v[96:97], v248 offset:16128
    ds_read_b64_tr_b16 v[98:99], v248 offset:16240
    s_waitcnt lgkmcnt(9)
    v_mfma_f32_32x32x16_bf16 v[16:31], v[128:131], v[80:83], v[16:31]
    ds_read_b64_tr_b16 v[100:101], v248 offset:16184
    ds_read_b64_tr_b16 v[102:103], v248 offset:16296
    ds_read_b64_tr_b16 v[104:105], v248 offset:23296
    ds_read_b64_tr_b16 v[106:107], v248 offset:23408
    s_waitcnt lgkmcnt(11)
    v_mfma_f32_32x32x16_bf16 v[32:47], v[128:131], v[84:87], v[32:47]
    ds_read_b64_tr_b16 v[108:109], v248 offset:23352
    ds_read_b64_tr_b16 v[110:111], v248 offset:23464
    s_waitcnt lgkmcnt(11)
    v_mfma_f32_32x32x16_bf16 v[48:63], v[128:131], v[88:91], v[48:63]
    s_waitcnt lgkmcnt(9)
    v_mfma_f32_32x32x16_bf16 v[64:79], v[128:131], v[92:95], v[64:79]
    ds_read_b128 v[136:139], v246 offset:16384
    ds_read_b64_tr_b16 v[80:81], v248 offset:17920
    ds_read_b64_tr_b16 v[82:83], v248 offset:18032
    s_waitcnt lgkmcnt(9)
    v_mfma_f32_32x32x16_bf16 v[16:31], v[132:135], v[96:99], v[16:31]
    ds_read_b64_tr_b16 v[84:85], v248 offset:17976
    ds_read_b64_tr_b16 v[86:87], v248 offset:18088
    ds_read_b64_tr_b16 v[88:89], v248 offset:25088
    ds_read_b64_tr_b16 v[90:91], v248 offset:25200
    s_waitcnt lgkmcnt(11)
    v_mfma_f32_32x32x16_bf16 v[32:47], v[132:135], v[100:103], v[32:47]
    ds_read_b64_tr_b16 v[92:93], v248 offset:25144
    ds_read_b64_tr_b16 v[94:95], v248 offset:25256
    s_waitcnt lgkmcnt(11)
    v_mfma_f32_32x32x16_bf16 v[48:63], v[132:135], v[104:107], v[48:63]
    s_waitcnt lgkmcnt(9)
    v_mfma_f32_32x32x16_bf16 v[64:79], v[132:135], v[108:111], v[64:79]
    ds_read_b128 v[140:143], v247 offset:16384
    ds_read_b64_tr_b16 v[96:97], v248 offset:19712
    ds_read_b64_tr_b16 v[98:99], v248 offset:19824
    s_waitcnt lgkmcnt(9)
    v_mfma_f32_32x32x16_bf16 v[16:31], v[136:139], v[80:83], v[16:31]
    ds_read_b64_tr_b16 v[100:101], v248 offset:19768
    ds_read_b64_tr_b16 v[102:103], v248 offset:19880
    ds_read_b64_tr_b16 v[104:105], v248 offset:26880
    ds_read_b64_tr_b16 v[106:107], v248 offset:26992
    s_waitcnt lgkmcnt(11)
    v_mfma_f32_32x32x16_bf16 v[32:47], v[136:139], v[84:87], v[32:47]
    ds_read_b64_tr_b16 v[108:109], v248 offset:26936
    ds_read_b64_tr_b16 v[110:111], v248 offset:27048
    s_waitcnt lgkmcnt(11)
    v_mfma_f32_32x32x16_bf16 v[48:63], v[136:139], v[88:91], v[48:63]
    s_waitcnt lgkmcnt(9)
    v_mfma_f32_32x32x16_bf16 v[64:79], v[136:139], v[92:95], v[64:79]
    s_barrier
    ds_read_b128 v[144:147], v244 offset:32768
    ds_read_b64_tr_b16 v[80:81], v248 offset:28672
    ds_read_b64_tr_b16 v[82:83], v248 offset:28784
    s_waitcnt lgkmcnt(9)
    v_mfma_f32_32x32x16_bf16 v[16:31], v[140:143], v[96:99], v[16:31]
    ds_read_b64_tr_b16 v[84:85], v248 offset:28728
    ds_read_b64_tr_b16 v[86:87], v248 offset:28840
    ds_read_b64_tr_b16 v[88:89], v248 offset:35840
    ds_read_b64_tr_b16 v[90:91], v248 offset:35952
    s_waitcnt lgkmcnt(11)
    v_mfma_f32_32x32x16_bf16 v[32:47], v[140:143], v[100:103], v[32:47]
    ds_read_b64_tr_b16 v[92:93], v248 offset:35896
    ds_read_b64_tr_b16 v[94:95], v248 offset:36008
    s_waitcnt lgkmcnt(11)
    v_mfma_f32_32x32x16_bf16 v[48:63], v[140:143], v[104:107], v[48:63]
    s_waitcnt lgkmcnt(9)
    v_mfma_f32_32x32x16_bf16 v[64:79], v[140:143], v[108:111], v[64:79]
    ds_read_b128 v[148:151], v245 offset:32768
    ds_read_b64_tr_b16 v[96:97], v248 offset:30464
    ds_read_b64_tr_b16 v[98:99], v248 offset:30576
    s_waitcnt lgkmcnt(9)
    v_mfma_f32_32x32x16_bf16 v[16:31], v[144:147], v[80:83], v[16:31]
    ds_read_b64_tr_b16 v[100:101], v248 offset:30520
    ds_read_b64_tr_b16 v[102:103], v248 offset:30632
    ds_read_b64_tr_b16 v[104:105], v248 offset:37632
    ds_read_b64_tr_b16 v[106:107], v248 offset:37744
    s_waitcnt lgkmcnt(11)
    v_mfma_f32_32x32x16_bf16 v[32:47], v[144:147], v[84:87], v[32:47]
    ds_read_b64_tr_b16 v[108:109], v248 offset:37688
    ds_read_b64_tr_b16 v[110:111], v248 offset:37800
    s_waitcnt lgkmcnt(11)
    v_mfma_f32_32x32x16_bf16 v[48:63], v[144:147], v[88:91], v[48:63]
    s_waitcnt lgkmcnt(9)
    v_mfma_f32_32x32x16_bf16 v[64:79], v[144:147], v[92:95], v[64:79]
    ds_read_b128 v[152:155], v246 offset:32768
    ds_read_b64_tr_b16 v[80:81], v248 offset:32256
    ds_read_b64_tr_b16 v[82:83], v248 offset:32368
    s_waitcnt lgkmcnt(9)
    v_mfma_f32_32x32x16_bf16 v[16:31], v[148:151], v[96:99], v[16:31]
    ds_read_b64_tr_b16 v[84:85], v248 offset:32312
    ds_read_b64_tr_b16 v[86:87], v248 offset:32424
    ds_read_b64_tr_b16 v[88:89], v248 offset:39424
    ds_read_b64_tr_b16 v[90:91], v248 offset:39536
    s_waitcnt lgkmcnt(11)
    v_mfma_f32_32x32x16_bf16 v[32:47], v[148:151], v[100:103], v[32:47]
    ds_read_b64_tr_b16 v[92:93], v248 offset:39480
    ds_read_b64_tr_b16 v[94:95], v248 offset:39592
    s_waitcnt lgkmcnt(11)
    v_mfma_f32_32x32x16_bf16 v[48:63], v[148:151], v[104:107], v[48:63]
    s_waitcnt lgkmcnt(9)
    v_mfma_f32_32x32x16_bf16 v[64:79], v[148:151], v[108:111], v[64:79]
    ds_read_b128 v[156:159], v247 offset:32768
    ds_read_b64_tr_b16 v[96:97], v248 offset:34048
    ds_read_b64_tr_b16 v[98:99], v248 offset:34160
    s_waitcnt lgkmcnt(9)
    v_mfma_f32_32x32x16_bf16 v[16:31], v[152:155], v[80:83], v[16:31]
    ds_read_b64_tr_b16 v[100:101], v248 offset:34104
    ds_read_b64_tr_b16 v[102:103], v248 offset:34216
    ds_read_b64_tr_b16 v[104:105], v248 offset:41216
    ds_read_b64_tr_b16 v[106:107], v248 offset:41328
    s_waitcnt lgkmcnt(11)
    v_mfma_f32_32x32x16_bf16 v[32:47], v[152:155], v[84:87], v[32:47]
    ds_read_b64_tr_b16 v[108:109], v248 offset:41272
    ds_read_b64_tr_b16 v[110:111], v248 offset:41384
    s_waitcnt lgkmcnt(11)
    v_mfma_f32_32x32x16_bf16 v[48:63], v[152:155], v[88:91], v[48:63]
    s_waitcnt lgkmcnt(9)
    v_mfma_f32_32x32x16_bf16 v[64:79], v[152:155], v[92:95], v[64:79]
    s_barrier
    ds_read_b128 v[160:163], v244 offset:49152
    ds_read_b64_tr_b16 v[80:81], v248 offset:43008
    ds_read_b64_tr_b16 v[82:83], v248 offset:43120
    s_waitcnt lgkmcnt(9)
    v_mfma_f32_32x32x16_bf16 v[16:31], v[156:159], v[96:99], v[16:31]
    ds_read_b64_tr_b16 v[84:85], v248 offset:43064
    ds_read_b64_tr_b16 v[86:87], v248 offset:43176
    ds_read_b64_tr_b16 v[88:89], v248 offset:50176
    ds_read_b64_tr_b16 v[90:91], v248 offset:50288
    s_waitcnt lgkmcnt(11)
    v_mfma_f32_32x32x16_bf16 v[32:47], v[156:159], v[100:103], v[32:47]
    ds_read_b64_tr_b16 v[92:93], v248 offset:50232
    ds_read_b64_tr_b16 v[94:95], v248 offset:50344
    s_waitcnt lgkmcnt(11)
    v_mfma_f32_32x32x16_bf16 v[48:63], v[156:159], v[104:107], v[48:63]
    s_waitcnt lgkmcnt(9)
    v_mfma_f32_32x32x16_bf16 v[64:79], v[156:159], v[108:111], v[64:79]
    ds_read_b128 v[164:167], v245 offset:49152
    ds_read_b64_tr_b16 v[96:97], v248 offset:44800
    ds_read_b64_tr_b16 v[98:99], v248 offset:44912
    s_waitcnt lgkmcnt(9)
    v_mfma_f32_32x32x16_bf16 v[16:31], v[160:163], v[80:83], v[16:31]
    ds_read_b64_tr_b16 v[100:101], v248 offset:44856
    ds_read_b64_tr_b16 v[102:103], v248 offset:44968
    ds_read_b64_tr_b16 v[104:105], v248 offset:51968
    ds_read_b64_tr_b16 v[106:107], v248 offset:52080
    s_waitcnt lgkmcnt(11)
    v_mfma_f32_32x32x16_bf16 v[32:47], v[160:163], v[84:87], v[32:47]
    ds_read_b64_tr_b16 v[108:109], v248 offset:52024
    ds_read_b64_tr_b16 v[110:111], v248 offset:52136
    s_waitcnt lgkmcnt(11)
    v_mfma_f32_32x32x16_bf16 v[48:63], v[160:163], v[88:91], v[48:63]
    s_waitcnt lgkmcnt(9)
    v_mfma_f32_32x32x16_bf16 v[64:79], v[160:163], v[92:95], v[64:79]
    ds_read_b128 v[168:171], v246 offset:49152
    ds_read_b64_tr_b16 v[80:81], v248 offset:46592
    ds_read_b64_tr_b16 v[82:83], v248 offset:46704
    s_waitcnt lgkmcnt(9)
    v_mfma_f32_32x32x16_bf16 v[16:31], v[164:167], v[96:99], v[16:31]
    ds_read_b64_tr_b16 v[84:85], v248 offset:46648
    ds_read_b64_tr_b16 v[86:87], v248 offset:46760
    ds_read_b64_tr_b16 v[88:89], v248 offset:53760
    ds_read_b64_tr_b16 v[90:91], v248 offset:53872
    s_waitcnt lgkmcnt(11)
    v_mfma_f32_32x32x16_bf16 v[32:47], v[164:167], v[100:103], v[32:47]
    ds_read_b64_tr_b16 v[92:93], v248 offset:53816
    ds_read_b64_tr_b16 v[94:95], v248 offset:53928
    s_waitcnt lgkmcnt(11)
    v_mfma_f32_32x32x16_bf16 v[48:63], v[164:167], v[104:107], v[48:63]
    s_waitcnt lgkmcnt(9)
    v_mfma_f32_32x32x16_bf16 v[64:79], v[164:167], v[108:111], v[64:79]
    ds_read_b128 v[172:175], v247 offset:49152
    ds_read_b64_tr_b16 v[96:97], v248 offset:48384
    ds_read_b64_tr_b16 v[98:99], v248 offset:48496
    s_waitcnt lgkmcnt(9)
    v_mfma_f32_32x32x16_bf16 v[16:31], v[168:171], v[80:83], v[16:31]
    ds_read_b64_tr_b16 v[100:101], v248 offset:48440
    ds_read_b64_tr_b16 v[102:103], v248 offset:48552
    ds_read_b64_tr_b16 v[104:105], v248 offset:55552
    ds_read_b64_tr_b16 v[106:107], v248 offset:55664
    s_waitcnt lgkmcnt(11)
    v_mfma_f32_32x32x16_bf16 v[32:47], v[168:171], v[84:87], v[32:47]
    ds_read_b64_tr_b16 v[108:109], v248 offset:55608
    ds_read_b64_tr_b16 v[110:111], v248 offset:55720
    s_waitcnt lgkmcnt(11)
    v_mfma_f32_32x32x16_bf16 v[48:63], v[168:171], v[88:91], v[48:63]
    s_waitcnt lgkmcnt(9)
    v_mfma_f32_32x32x16_bf16 v[64:79], v[168:171], v[92:95], v[64:79]
    s_barrier
    ds_read_b128 v[176:179], v244 offset:0
    ds_read_b64_tr_b16 v[80:81], v248 offset:0
    ds_read_b64_tr_b16 v[82:83], v248 offset:112
    s_waitcnt lgkmcnt(9)
    v_mfma_f32_32x32x16_bf16 v[16:31], v[172:175], v[96:99], v[16:31]
    ds_read_b64_tr_b16 v[84:85], v248 offset:56
    ds_read_b64_tr_b16 v[86:87], v248 offset:168
    ds_read_b64_tr_b16 v[88:89], v248 offset:7168
    ds_read_b64_tr_b16 v[90:91], v248 offset:7280
    s_waitcnt lgkmcnt(11)
    v_mfma_f32_32x32x16_bf16 v[32:47], v[172:175], v[100:103], v[32:47]
    ds_read_b64_tr_b16 v[92:93], v248 offset:7224
    ds_read_b64_tr_b16 v[94:95], v248 offset:7336
    s_waitcnt lgkmcnt(11)
    v_mfma_f32_32x32x16_bf16 v[48:63], v[172:175], v[104:107], v[48:63]
    s_waitcnt lgkmcnt(9)
    v_mfma_f32_32x32x16_bf16 v[64:79], v[172:175], v[108:111], v[64:79]
    ds_read_b128 v[180:183], v245 offset:0
    ds_read_b64_tr_b16 v[96:97], v248 offset:1792
    ds_read_b64_tr_b16 v[98:99], v248 offset:1904
    s_waitcnt lgkmcnt(9)
    v_mfma_f32_32x32x16_bf16 v[16:31], v[176:179], v[80:83], v[16:31]
    ds_read_b64_tr_b16 v[100:101], v248 offset:1848
    ds_read_b64_tr_b16 v[102:103], v248 offset:1960
    ds_read_b64_tr_b16 v[104:105], v248 offset:8960
    ds_read_b64_tr_b16 v[106:107], v248 offset:9072
    s_waitcnt lgkmcnt(11)
    v_mfma_f32_32x32x16_bf16 v[32:47], v[176:179], v[84:87], v[32:47]
    ds_read_b64_tr_b16 v[108:109], v248 offset:9016
    ds_read_b64_tr_b16 v[110:111], v248 offset:9128
    s_waitcnt lgkmcnt(11)
    v_mfma_f32_32x32x16_bf16 v[48:63], v[176:179], v[88:91], v[48:63]
    s_waitcnt lgkmcnt(9)
    v_mfma_f32_32x32x16_bf16 v[64:79], v[176:179], v[92:95], v[64:79]
    ds_read_b128 v[184:187], v246 offset:0
    ds_read_b64_tr_b16 v[80:81], v248 offset:3584
    ds_read_b64_tr_b16 v[82:83], v248 offset:3696
    s_waitcnt lgkmcnt(9)
    v_mfma_f32_32x32x16_bf16 v[16:31], v[180:183], v[96:99], v[16:31]
    ds_read_b64_tr_b16 v[84:85], v248 offset:3640
    ds_read_b64_tr_b16 v[86:87], v248 offset:3752
    ds_read_b64_tr_b16 v[88:89], v248 offset:10752
    ds_read_b64_tr_b16 v[90:91], v248 offset:10864
    s_waitcnt lgkmcnt(11)
    v_mfma_f32_32x32x16_bf16 v[32:47], v[180:183], v[100:103], v[32:47]
    ds_read_b64_tr_b16 v[92:93], v248 offset:10808
    ds_read_b64_tr_b16 v[94:95], v248 offset:10920
    s_waitcnt lgkmcnt(11)
    v_mfma_f32_32x32x16_bf16 v[48:63], v[180:183], v[104:107], v[48:63]
    s_waitcnt lgkmcnt(9)
    v_mfma_f32_32x32x16_bf16 v[64:79], v[180:183], v[108:111], v[64:79]
    ds_read_b128 v[188:191], v247 offset:0
    ds_read_b64_tr_b16 v[96:97], v248 offset:5376
    ds_read_b64_tr_b16 v[98:99], v248 offset:5488
    s_waitcnt lgkmcnt(9)
    v_mfma_f32_32x32x16_bf16 v[16:31], v[184:187], v[80:83], v[16:31]
    ds_read_b64_tr_b16 v[100:101], v248 offset:5432
    ds_read_b64_tr_b16 v[102:103], v248 offset:5544
    ds_read_b64_tr_b16 v[104:105], v248 offset:12544
    ds_read_b64_tr_b16 v[106:107], v248 offset:12656
    s_waitcnt lgkmcnt(11)
    v_mfma_f32_32x32x16_bf16 v[32:47], v[184:187], v[84:87], v[32:47]
    ds_read_b64_tr_b16 v[108:109], v248 offset:12600
    ds_read_b64_tr_b16 v[110:111], v248 offset:12712
    s_waitcnt lgkmcnt(11)
    v_mfma_f32_32x32x16_bf16 v[48:63], v[184:187], v[88:91], v[48:63]
    s_waitcnt lgkmcnt(9)
    v_mfma_f32_32x32x16_bf16 v[64:79], v[184:187], v[92:95], v[64:79]
    s_barrier
    ds_read_b128 v[192:195], v244 offset:16384
    ds_read_b64_tr_b16 v[80:81], v248 offset:14336
    ds_read_b64_tr_b16 v[82:83], v248 offset:14448
    s_waitcnt lgkmcnt(9)
    v_mfma_f32_32x32x16_bf16 v[16:31], v[188:191], v[96:99], v[16:31]
    ds_read_b64_tr_b16 v[84:85], v248 offset:14392
    ds_read_b64_tr_b16 v[86:87], v248 offset:14504
    ds_read_b64_tr_b16 v[88:89], v248 offset:21504
    ds_read_b64_tr_b16 v[90:91], v248 offset:21616
    s_waitcnt lgkmcnt(11)
    v_mfma_f32_32x32x16_bf16 v[32:47], v[188:191], v[100:103], v[32:47]
    ds_read_b64_tr_b16 v[92:93], v248 offset:21560
    ds_read_b64_tr_b16 v[94:95], v248 offset:21672
    s_waitcnt lgkmcnt(11)
    v_mfma_f32_32x32x16_bf16 v[48:63], v[188:191], v[104:107], v[48:63]
    s_waitcnt lgkmcnt(9)
    v_mfma_f32_32x32x16_bf16 v[64:79], v[188:191], v[108:111], v[64:79]
    ds_read_b128 v[196:199], v245 offset:16384
    ds_read_b64_tr_b16 v[96:97], v248 offset:16128
    ds_read_b64_tr_b16 v[98:99], v248 offset:16240
    s_waitcnt lgkmcnt(9)
    v_mfma_f32_32x32x16_bf16 v[16:31], v[192:195], v[80:83], v[16:31]
    ds_read_b64_tr_b16 v[100:101], v248 offset:16184
    ds_read_b64_tr_b16 v[102:103], v248 offset:16296
    ds_read_b64_tr_b16 v[104:105], v248 offset:23296
    ds_read_b64_tr_b16 v[106:107], v248 offset:23408
    s_waitcnt lgkmcnt(11)
    v_mfma_f32_32x32x16_bf16 v[32:47], v[192:195], v[84:87], v[32:47]
    ds_read_b64_tr_b16 v[108:109], v248 offset:23352
    ds_read_b64_tr_b16 v[110:111], v248 offset:23464
    s_waitcnt lgkmcnt(11)
    v_mfma_f32_32x32x16_bf16 v[48:63], v[192:195], v[88:91], v[48:63]
    s_waitcnt lgkmcnt(9)
    v_mfma_f32_32x32x16_bf16 v[64:79], v[192:195], v[92:95], v[64:79]
    ds_read_b128 v[200:203], v246 offset:16384
    ds_read_b64_tr_b16 v[80:81], v248 offset:17920
    ds_read_b64_tr_b16 v[82:83], v248 offset:18032
    s_waitcnt lgkmcnt(9)
    v_mfma_f32_32x32x16_bf16 v[16:31], v[196:199], v[96:99], v[16:31]
    ds_read_b64_tr_b16 v[84:85], v248 offset:17976
    ds_read_b64_tr_b16 v[86:87], v248 offset:18088
    ds_read_b64_tr_b16 v[88:89], v248 offset:25088
    ds_read_b64_tr_b16 v[90:91], v248 offset:25200
    s_waitcnt lgkmcnt(11)
    v_mfma_f32_32x32x16_bf16 v[32:47], v[196:199], v[100:103], v[32:47]
    ds_read_b64_tr_b16 v[92:93], v248 offset:25144
    ds_read_b64_tr_b16 v[94:95], v248 offset:25256
    s_waitcnt lgkmcnt(11)
    v_mfma_f32_32x32x16_bf16 v[48:63], v[196:199], v[104:107], v[48:63]
    s_waitcnt lgkmcnt(9)
    v_mfma_f32_32x32x16_bf16 v[64:79], v[196:199], v[108:111], v[64:79]
    ds_read_b128 v[204:207], v247 offset:16384
    ds_read_b64_tr_b16 v[96:97], v248 offset:19712
    ds_read_b64_tr_b16 v[98:99], v248 offset:19824
    s_waitcnt lgkmcnt(9)
    v_mfma_f32_32x32x16_bf16 v[16:31], v[200:203], v[80:83], v[16:31]
    ds_read_b64_tr_b16 v[100:101], v248 offset:19768
    ds_read_b64_tr_b16 v[102:103], v248 offset:19880
    ds_read_b64_tr_b16 v[104:105], v248 offset:26880
    ds_read_b64_tr_b16 v[106:107], v248 offset:26992
    s_waitcnt lgkmcnt(11)
    v_mfma_f32_32x32x16_bf16 v[32:47], v[200:203], v[84:87], v[32:47]
    ds_read_b64_tr_b16 v[108:109], v248 offset:26936
    ds_read_b64_tr_b16 v[110:111], v248 offset:27048
    s_waitcnt lgkmcnt(11)
    v_mfma_f32_32x32x16_bf16 v[48:63], v[200:203], v[88:91], v[48:63]
    s_waitcnt lgkmcnt(9)
    v_mfma_f32_32x32x16_bf16 v[64:79], v[200:203], v[92:95], v[64:79]
    s_barrier
    ds_read_b128 v[208:211], v244 offset:32768
    ds_read_b64_tr_b16 v[80:81], v248 offset:28672
    ds_read_b64_tr_b16 v[82:83], v248 offset:28784
    s_waitcnt lgkmcnt(9)
    v_mfma_f32_32x32x16_bf16 v[16:31], v[204:207], v[96:99], v[16:31]
    ds_read_b64_tr_b16 v[84:85], v248 offset:28728
    ds_read_b64_tr_b16 v[86:87], v248 offset:28840
    ds_read_b64_tr_b16 v[88:89], v248 offset:35840
    ds_read_b64_tr_b16 v[90:91], v248 offset:35952
    s_waitcnt lgkmcnt(11)
    v_mfma_f32_32x32x16_bf16 v[32:47], v[204:207], v[100:103], v[32:47]
    ds_read_b64_tr_b16 v[92:93], v248 offset:35896
    ds_read_b64_tr_b16 v[94:95], v248 offset:36008
    s_waitcnt lgkmcnt(11)
    v_mfma_f32_32x32x16_bf16 v[48:63], v[204:207], v[104:107], v[48:63]
    s_waitcnt lgkmcnt(9)
    v_mfma_f32_32x32x16_bf16 v[64:79], v[204:207], v[108:111], v[64:79]
    ds_read_b128 v[212:215], v245 offset:32768
    ds_read_b64_tr_b16 v[96:97], v248 offset:30464
    ds_read_b64_tr_b16 v[98:99], v248 offset:30576
    s_waitcnt lgkmcnt(9)
    v_mfma_f32_32x32x16_bf16 v[16:31], v[208:211], v[80:83], v[16:31]
    ds_read_b64_tr_b16 v[100:101], v248 offset:30520
    ds_read_b64_tr_b16 v[102:103], v248 offset:30632
    ds_read_b64_tr_b16 v[104:105], v248 offset:37632
    ds_read_b64_tr_b16 v[106:107], v248 offset:37744
    s_waitcnt lgkmcnt(11)
    v_mfma_f32_32x32x16_bf16 v[32:47], v[208:211], v[84:87], v[32:47]
    ds_read_b64_tr_b16 v[108:109], v248 offset:37688
    ds_read_b64_tr_b16 v[110:111], v248 offset:37800
    s_waitcnt lgkmcnt(11)
    v_mfma_f32_32x32x16_bf16 v[48:63], v[208:211], v[88:91], v[48:63]
    s_waitcnt lgkmcnt(9)
    v_mfma_f32_32x32x16_bf16 v[64:79], v[208:211], v[92:95], v[64:79]
    ds_read_b128 v[216:219], v246 offset:32768
    ds_read_b64_tr_b16 v[80:81], v248 offset:32256
    ds_read_b64_tr_b16 v[82:83], v248 offset:32368
    s_waitcnt lgkmcnt(9)
    v_mfma_f32_32x32x16_bf16 v[16:31], v[212:215], v[96:99], v[16:31]
    ds_read_b64_tr_b16 v[84:85], v248 offset:32312
    ds_read_b64_tr_b16 v[86:87], v248 offset:32424
    ds_read_b64_tr_b16 v[88:89], v248 offset:39424
    ds_read_b64_tr_b16 v[90:91], v248 offset:39536
    s_waitcnt lgkmcnt(11)
    v_mfma_f32_32x32x16_bf16 v[32:47], v[212:215], v[100:103], v[32:47]
    ds_read_b64_tr_b16 v[92:93], v248 offset:39480
    ds_read_b64_tr_b16 v[94:95], v248 offset:39592
    s_waitcnt lgkmcnt(11)
    v_mfma_f32_32x32x16_bf16 v[48:63], v[212:215], v[104:107], v[48:63]
    s_waitcnt lgkmcnt(9)
    v_mfma_f32_32x32x16_bf16 v[64:79], v[212:215], v[108:111], v[64:79]
    ds_read_b128 v[220:223], v247 offset:32768
    ds_read_b64_tr_b16 v[96:97], v248 offset:34048
    ds_read_b64_tr_b16 v[98:99], v248 offset:34160
    s_waitcnt lgkmcnt(9)
    v_mfma_f32_32x32x16_bf16 v[16:31], v[216:219], v[80:83], v[16:31]
    ds_read_b64_tr_b16 v[100:101], v248 offset:34104
    ds_read_b64_tr_b16 v[102:103], v248 offset:34216
    ds_read_b64_tr_b16 v[104:105], v248 offset:41216
    ds_read_b64_tr_b16 v[106:107], v248 offset:41328
    s_waitcnt lgkmcnt(11)
    v_mfma_f32_32x32x16_bf16 v[32:47], v[216:219], v[84:87], v[32:47]
    ds_read_b64_tr_b16 v[108:109], v248 offset:41272
    ds_read_b64_tr_b16 v[110:111], v248 offset:41384
    s_waitcnt lgkmcnt(11)
    v_mfma_f32_32x32x16_bf16 v[48:63], v[216:219], v[88:91], v[48:63]
    s_waitcnt lgkmcnt(9)
    v_mfma_f32_32x32x16_bf16 v[64:79], v[216:219], v[92:95], v[64:79]
    s_barrier
    s_waitcnt lgkmcnt(6)
    v_mfma_f32_32x32x16_bf16 v[16:31], v[220:223], v[96:99], v[16:31]
    s_waitcnt lgkmcnt(4)
    v_mfma_f32_32x32x16_bf16 v[32:47], v[220:223], v[100:103], v[32:47]
    s_waitcnt lgkmcnt(2)
    v_mfma_f32_32x32x16_bf16 v[48:63], v[220:223], v[104:107], v[48:63]
    s_waitcnt lgkmcnt(0)
    v_mfma_f32_32x32x16_bf16 v[64:79], v[220:223], v[108:111], v[64:79]
    s_barrier
    s_load_dword s53, s[80:81], 0
    s_mov_b32 s44, 0
    s_mov_b32 s45, -1
    s_mov_b32 s54, 0x10000000
    s_mov_b32 s55, 0x10000000
    s_mov_b32 s56, 0xf0000000
    s_mov_b32 s57, 0xf0000000
    v_mov_b32 v240, 0x3f803f80
    v_mov_b32 v241, 0x3f80
    s_lshl_b32 s46, s23, 2
    s_add_u32 s46, s46, 32
    s_load_dword s42, s[80:81], s46
    s_mov_b32 s46, 0x3fb8aa3b
    s_mov_b32 s47, 0x3fb8aa3b
    s_mov_b32 s48, 0x358637bd
    s_mov_b32 s49, 0x358637bd
    v_pk_mul_f32 v[224:225], v[16:17], s[46:47]
    v_pk_mul_f32 v[226:227], v[18:19], s[46:47]
    v_pk_mul_f32 v[228:229], v[20:21], s[46:47]
    v_pk_mul_f32 v[230:231], v[22:23], s[46:47]
    v_pk_mul_f32 v[232:233], v[24:25], s[46:47]
    v_pk_mul_f32 v[234:235], v[26:27], s[46:47]
    v_pk_mul_f32 v[236:237], v[28:29], s[46:47]
    v_pk_mul_f32 v[238:239], v[30:31], s[46:47]
    v_exp_f32 v224, v224 clamp
    v_exp_f32 v225, v225 clamp
    v_exp_f32 v226, v226 clamp
    v_exp_f32 v227, v227 clamp
    v_exp_f32 v228, v228 clamp
    v_exp_f32 v229, v229 clamp
    v_exp_f32 v230, v230 clamp
    v_exp_f32 v231, v231 clamp
    v_exp_f32 v232, v232 clamp
    v_exp_f32 v233, v233 clamp
    v_exp_f32 v234, v234 clamp
    v_exp_f32 v235, v235 clamp
    v_exp_f32 v236, v236 clamp
    v_exp_f32 v237, v237 clamp
    v_exp_f32 v238, v238 clamp
    v_exp_f32 v239, v239 clamp
    v_max_f32 v16, 0, v16
    v_max_f32 v17, 0, v17
    v_max_f32 v18, 0, v18
    v_max_f32 v19, 0, v19
    v_max_f32 v20, 0, v20
    v_max_f32 v21, 0, v21
    v_max_f32 v22, 0, v22
    v_max_f32 v23, 0, v23
    v_max_f32 v24, 0, v24
    v_max_f32 v25, 0, v25
    v_max_f32 v26, 0, v26
    v_max_f32 v27, 0, v27
    v_max_f32 v28, 0, v28
    v_max_f32 v29, 0, v29
    v_max_f32 v30, 0, v30
    v_max_f32 v31, 0, v31
    v_pk_add_f32 v[224:225], v[224:225], s[48:49]
    v_pk_add_f32 v[226:227], v[226:227], s[48:49]
    v_pk_add_f32 v[228:229], v[228:229], s[48:49]
    v_pk_add_f32 v[230:231], v[230:231], s[48:49]
    v_pk_add_f32 v[232:233], v[232:233], s[48:49]
    v_pk_add_f32 v[234:235], v[234:235], s[48:49]
    v_pk_add_f32 v[236:237], v[236:237], s[48:49]
    v_pk_add_f32 v[238:239], v[238:239], s[48:49]
    v_pk_add_f32 v[16:17], v[16:17], v[224:225]
    v_pk_add_f32 v[18:19], v[18:19], v[226:227]
    v_pk_add_f32 v[20:21], v[20:21], v[228:229]
    v_pk_add_f32 v[22:23], v[22:23], v[230:231]
    v_pk_add_f32 v[24:25], v[24:25], v[232:233]
    v_pk_add_f32 v[26:27], v[26:27], v[234:235]
    v_pk_add_f32 v[28:29], v[28:29], v[236:237]
    v_pk_add_f32 v[30:31], v[30:31], v[238:239]
    v_cvt_pk_bf16_f32 v16, v16, v17
    v_cvt_pk_bf16_f32 v17, v18, v19
    v_cvt_pk_bf16_f32 v18, v20, v21
    v_cvt_pk_bf16_f32 v19, v22, v23
    v_cvt_pk_bf16_f32 v20, v24, v25
    v_cvt_pk_bf16_f32 v21, v26, v27
    v_cvt_pk_bf16_f32 v22, v28, v29
    v_cvt_pk_bf16_f32 v23, v30, v31
    v_cndmask_b32_e64 v16, v16, 0, s[56:57]
    v_cndmask_b32_e64 v17, v17, 0, s[56:57]
    v_cndmask_b32_e64 v18, v18, 0, s[56:57]
    v_cndmask_b32_e64 v19, v19, 0, s[56:57]
    v_cndmask_b32_e64 v20, v20, 0, s[56:57]
    v_cndmask_b32_e64 v21, v21, 0, s[56:57]
    v_cndmask_b32_e64 v22, v22, 0, s[56:57]
    v_cndmask_b32_e64 v23, v23, 0, s[56:57]
    v_cvt_pk_bf16_f32 v48, v48, v49
    v_cvt_pk_bf16_f32 v49, v50, v51
    v_cvt_pk_bf16_f32 v50, v52, v53
    v_cvt_pk_bf16_f32 v51, v54, v55
    v_cvt_pk_bf16_f32 v52, v56, v57
    v_cvt_pk_bf16_f32 v53, v58, v59
    v_cvt_pk_bf16_f32 v54, v60, v61
    v_cvt_pk_bf16_f32 v55, v62, v63
    v_cndmask_b32_e64 v48, v48, v240, s[54:55]
    v_cndmask_b32_e64 v49, v49, v240, s[54:55]
    v_cndmask_b32_e64 v50, v50, v240, s[54:55]
    v_cndmask_b32_e64 v51, v51, v240, s[54:55]
    v_cndmask_b32_e64 v52, v52, v240, s[54:55]
    v_cndmask_b32_e64 v53, v53, v240, s[54:55]
    v_cndmask_b32_e64 v54, v54, v240, s[54:55]
    v_cndmask_b32_e64 v55, v55, v240, s[54:55]
    s_nop 1
    v_mfma_f32_32x32x16_bf16 v[80:95], v[16:19], v[48:51], 0
    v_mfma_f32_32x32x16_bf16 v[80:95], v[20:23], v[52:55], v[80:95]
    s_mov_b32 s46, 0x3fb8aa3b
    s_mov_b32 s47, 0x3fb8aa3b
    s_mov_b32 s48, 0x358637bd
    s_mov_b32 s49, 0x358637bd
    v_pk_mul_f32 v[224:225], v[32:33], s[46:47]
    v_pk_mul_f32 v[226:227], v[34:35], s[46:47]
    v_pk_mul_f32 v[228:229], v[36:37], s[46:47]
    v_pk_mul_f32 v[230:231], v[38:39], s[46:47]
    v_pk_mul_f32 v[232:233], v[40:41], s[46:47]
    v_pk_mul_f32 v[234:235], v[42:43], s[46:47]
    v_pk_mul_f32 v[236:237], v[44:45], s[46:47]
    v_pk_mul_f32 v[238:239], v[46:47], s[46:47]
    v_exp_f32 v224, v224 clamp
    v_exp_f32 v225, v225 clamp
    v_exp_f32 v226, v226 clamp
    v_exp_f32 v227, v227 clamp
    v_exp_f32 v228, v228 clamp
    v_exp_f32 v229, v229 clamp
    v_exp_f32 v230, v230 clamp
    v_exp_f32 v231, v231 clamp
    v_exp_f32 v232, v232 clamp
    v_exp_f32 v233, v233 clamp
    v_exp_f32 v234, v234 clamp
    v_exp_f32 v235, v235 clamp
    v_exp_f32 v236, v236 clamp
    v_exp_f32 v237, v237 clamp
    v_exp_f32 v238, v238 clamp
    v_exp_f32 v239, v239 clamp
    v_max_f32 v32, 0, v32
    v_max_f32 v33, 0, v33
    v_max_f32 v34, 0, v34
    v_max_f32 v35, 0, v35
    v_max_f32 v36, 0, v36
    v_max_f32 v37, 0, v37
    v_max_f32 v38, 0, v38
    v_max_f32 v39, 0, v39
    v_max_f32 v40, 0, v40
    v_max_f32 v41, 0, v41
    v_max_f32 v42, 0, v42
    v_max_f32 v43, 0, v43
    v_max_f32 v44, 0, v44
    v_max_f32 v45, 0, v45
    v_max_f32 v46, 0, v46
    v_max_f32 v47, 0, v47
    v_pk_add_f32 v[224:225], v[224:225], s[48:49]
    v_pk_add_f32 v[226:227], v[226:227], s[48:49]
    v_pk_add_f32 v[228:229], v[228:229], s[48:49]
    v_pk_add_f32 v[230:231], v[230:231], s[48:49]
    v_pk_add_f32 v[232:233], v[232:233], s[48:49]
    v_pk_add_f32 v[234:235], v[234:235], s[48:49]
    v_pk_add_f32 v[236:237], v[236:237], s[48:49]
    v_pk_add_f32 v[238:239], v[238:239], s[48:49]
    v_pk_add_f32 v[32:33], v[32:33], v[224:225]
    v_pk_add_f32 v[34:35], v[34:35], v[226:227]
    v_pk_add_f32 v[36:37], v[36:37], v[228:229]
    v_pk_add_f32 v[38:39], v[38:39], v[230:231]
    v_pk_add_f32 v[40:41], v[40:41], v[232:233]
    v_pk_add_f32 v[42:43], v[42:43], v[234:235]
    v_pk_add_f32 v[44:45], v[44:45], v[236:237]
    v_pk_add_f32 v[46:47], v[46:47], v[238:239]
    v_cvt_pk_bf16_f32 v32, v32, v33
    v_cvt_pk_bf16_f32 v33, v34, v35
    v_cvt_pk_bf16_f32 v34, v36, v37
    v_cvt_pk_bf16_f32 v35, v38, v39
    v_cvt_pk_bf16_f32 v36, v40, v41
    v_cvt_pk_bf16_f32 v37, v42, v43
    v_cvt_pk_bf16_f32 v38, v44, v45
    v_cvt_pk_bf16_f32 v39, v46, v47
    v_cndmask_b32_e64 v32, v32, 0, s[56:57]
    v_cndmask_b32_e64 v33, v33, 0, s[56:57]
    v_cndmask_b32_e64 v34, v34, 0, s[56:57]
    v_cndmask_b32_e64 v35, v35, 0, s[56:57]
    v_cndmask_b32_e64 v36, v36, 0, s[56:57]
    v_cndmask_b32_e64 v37, v37, 0, s[56:57]
    v_cndmask_b32_e64 v38, v38, 0, s[56:57]
    v_cndmask_b32_e64 v39, v39, 0, s[56:57]
    v_cvt_pk_bf16_f32 v64, v64, v65
    v_cvt_pk_bf16_f32 v65, v66, v67
    v_cvt_pk_bf16_f32 v66, v68, v69
    v_cvt_pk_bf16_f32 v67, v70, v71
    v_cvt_pk_bf16_f32 v68, v72, v73
    v_cvt_pk_bf16_f32 v69, v74, v75
    v_cvt_pk_bf16_f32 v70, v76, v77
    v_cvt_pk_bf16_f32 v71, v78, v79
    v_cndmask_b32_e64 v64, v64, v240, s[54:55]
    v_cndmask_b32_e64 v65, v65, v240, s[54:55]
    v_cndmask_b32_e64 v66, v66, v240, s[54:55]
    v_cndmask_b32_e64 v67, v67, v240, s[54:55]
    v_cndmask_b32_e64 v68, v68, v240, s[54:55]
    v_cndmask_b32_e64 v69, v69, v240, s[54:55]
    v_cndmask_b32_e64 v70, v70, v240, s[54:55]
    v_cndmask_b32_e64 v71, v71, v240, s[54:55]
    s_nop 1
    v_mfma_f32_32x32x16_bf16 v[96:111], v[32:35], v[64:67], 0
    v_mfma_f32_32x32x16_bf16 v[96:111], v[36:39], v[68:71], v[96:111]
    s_lshl_b32 s46, s20, 13
    s_add_u32 s46, s46, 114688
    v_add_u32 v5, s46, v2
    s_nop 7
    s_nop 7
    ds_write_b128 v5, v[80:83] offset:0
    ds_write_b128 v5, v[84:87] offset:1024
    ds_write_b128 v5, v[88:91] offset:2048
    ds_write_b128 v5, v[92:95] offset:3072
    ds_write_b128 v5, v[96:99] offset:4096
    ds_write_b128 v5, v[100:103] offset:5120
    ds_write_b128 v5, v[104:107] offset:6144
    ds_write_b128 v5, v[108:111] offset:7168
    v_mov_b32 v3, 61448
    v_mov_b32 v4, 1
    s_mov_b64 exec, 1
    ds_add_u32 v3, v4
    s_mov_b64 exec, -1
    s_mov_b32 s59, 2097152
    v_mov_b32 v3, 61448
L_cspin_55:
    ds_read_b32 v4, v3
    s_waitcnt lgkmcnt(0)
    v_readfirstlane_b32 s46, v4
    s_sub_u32 s59, s59, 1
    s_cbranch_scc1 L_cspun_56
    s_cmp_lt_u32 s46, 4
    s_cbranch_scc1 L_cspin_55
L_cspun_56:
    s_lshl_b32 s46, s20, 11
    s_add_u32 s46, s46, 114688
    v_add_u32 v5, s46, v2
    ds_read_b128 v[16:19], v5 offset:0
    ds_read_b128 v[20:23], v5 offset:1024
    ds_read_b128 v[24:27], v5 offset:8192
    ds_read_b128 v[28:31], v5 offset:9216
    ds_read_b128 v[32:35], v5 offset:16384
    ds_read_b128 v[36:39], v5 offset:17408
    ds_read_b128 v[40:43], v5 offset:24576
    ds_read_b128 v[44:47], v5 offset:25600
    s_waitcnt lgkmcnt(0)
    v_mov_b32 v3, 61452
    v_mov_b32 v4, 1
    s_mov_b64 exec, 1
    ds_add_u32 v3, v4
    s_mov_b64 exec, -1
    v_pk_add_f32 v[16:17], v[16:17], v[24:25]
    v_pk_add_f32 v[32:33], v[32:33], v[40:41]
    v_pk_add_f32 v[18:19], v[18:19], v[26:27]
    v_pk_add_f32 v[34:35], v[34:35], v[42:43]
    v_pk_add_f32 v[20:21], v[20:21], v[28:29]
    v_pk_add_f32 v[36:37], v[36:37], v[44:45]
    v_pk_add_f32 v[22:23], v[22:23], v[30:31]
    v_pk_add_f32 v[38:39], v[38:39], v[46:47]
    v_pk_add_f32 v[16:17], v[16:17], v[32:33]
    v_pk_add_f32 v[18:19], v[18:19], v[34:35]
    v_pk_add_f32 v[20:21], v[20:21], v[36:37]
    v_pk_add_f32 v[22:23], v[22:23], v[38:39]
    s_cmp_lg_u32 s42, 0
    s_cbranch_scc1 L_zok_57
    s_mov_b32 s59, 262144
    s_lshl_b32 s46, s23, 2
    s_add_u32 s46, s46, 32
    v_mov_b32 v4, 0
L_zpoll_58:
    buffer_load_dword v3, v4, s[96:99], s46 offen sc1
    s_waitcnt vmcnt(0)
    v_readfirstlane_b32 s42, v3
    s_sub_u32 s59, s59, 1
    s_cbranch_scc1 L_zok_57
    s_cmp_eq_u32 s42, 0
    s_cbranch_scc1 L_zpoll_58
L_zok_57:
    s_lshl_b32 s46, s23, 13
    s_lshl_b32 s47, s20, 11
    s_add_u32 s46, s46, s47
    s_add_u32 s46, s46, 10506240
    v_lshlrev_b32 v3, 2, v1
    buffer_atomic_add_f32 v16, v3, s[12:15], s46 offen offset:0
    buffer_atomic_add_f32 v17, v3, s[12:15], s46 offen offset:256
    buffer_atomic_add_f32 v18, v3, s[12:15], s46 offen offset:512
    buffer_atomic_add_f32 v19, v3, s[12:15], s46 offen offset:768
    buffer_atomic_add_f32 v20, v3, s[12:15], s46 offen offset:1024
    buffer_atomic_add_f32 v21, v3, s[12:15], s46 offen offset:1280
    buffer_atomic_add_f32 v22, v3, s[12:15], s46 offen offset:1536
    buffer_atomic_add_f32 v23, v3, s[12:15], s46 offen offset:1792
    s_waitcnt lgkmcnt(0)
    s_barrier
    s_cmp_eq_u32 s23, 0
    s_cbranch_scc1 L_lin_gate
    ds_read_b64_tr_b16 v[80:81], v249 offset:0
    ds_read_b64_tr_b16 v[82:83], v249 offset:112
    ds_read_b64_tr_b16 v[84:85], v249 offset:56
    ds_read_b64_tr_b16 v[86:87], v249 offset:168
    ds_read_b64_tr_b16 v[88:89], v249 offset:1792
    ds_read_b64_tr_b16 v[90:91], v249 offset:1904
    ds_read_b64_tr_b16 v[92:93], v249 offset:1848
    ds_read_b64_tr_b16 v[94:95], v249 offset:1960
    ds_read_b64_tr_b16 v[96:97], v249 offset:3584
    ds_read_b64_tr_b16 v[98:99], v249 offset:3696
    ds_read_b64_tr_b16 v[100:101], v249 offset:3640
    ds_read_b64_tr_b16 v[102:103], v249 offset:3752
    ds_read_b64_tr_b16 v[104:105], v249 offset:5376
    ds_read_b64_tr_b16 v[106:107], v249 offset:5488
    ds_read_b64_tr_b16 v[108:109], v249 offset:5432
    ds_read_b64_tr_b16 v[110:111], v249 offset:5544
    s_waitcnt lgkmcnt(12)
    v_mfma_f32_32x32x16_bf16 v[16:31], v[80:83], v[112:115], 0
    v_mfma_f32_32x32x16_bf16 v[32:47], v[84:87], v[112:115], 0
    ds_read_b64_tr_b16 v[80:81], v249 offset:7168
    ds_read_b64_tr_b16 v[82:83], v249 offset:7280
    ds_read_b64_tr_b16 v[84:85], v249 offset:7224
    ds_read_b64_tr_b16 v[86:87], v249 offset:7336
    s_waitcnt lgkmcnt(12)
    v_mfma_f32_32x32x16_bf16 v[16:31], v[88:91], v[116:119], v[16:31]
    v_mfma_f32_32x32x16_bf16 v[32:47], v[92:95], v[116:119], v[32:47]
    ds_read_b64_tr_b16 v[88:89], v249 offset:8960
    ds_read_b64_tr_b16 v[90:91], v249 offset:9072
    ds_read_b64_tr_b16 v[92:93], v249 offset:9016
    ds_read_b64_tr_b16 v[94:95], v249 offset:9128
    s_waitcnt lgkmcnt(12)
    v_mfma_f32_32x32x16_bf16 v[16:31], v[96:99], v[120:123], v[16:31]
    v_mfma_f32_32x32x16_bf16 v[32:47], v[100:103], v[120:123], v[32:47]
    ds_read_b64_tr_b16 v[96:97], v249 offset:10752
    ds_read_b64_tr_b16 v[98:99], v249 offset:10864
    ds_read_b64_tr_b16 v[100:101], v249 offset:10808
    ds_read_b64_tr_b16 v[102:103], v249 offset:10920
    s_waitcnt lgkmcnt(12)
    v_mfma_f32_32x32x16_bf16 v[16:31], v[104:107], v[124:127], v[16:31]
    v_mfma_f32_32x32x16_bf16 v[32:47], v[108:111], v[124:127], v[32:47]
    ds_read_b64_tr_b16 v[104:105], v249 offset:12544
    ds_read_b64_tr_b16 v[106:107], v249 offset:12656
    ds_read_b64_tr_b16 v[108:109], v249 offset:12600
    ds_read_b64_tr_b16 v[110:111], v249 offset:12712
    s_waitcnt lgkmcnt(12)
    v_mfma_f32_32x32x16_bf16 v[16:31], v[80:83], v[128:131], v[16:31]
    v_mfma_f32_32x32x16_bf16 v[32:47], v[84:87], v[128:131], v[32:47]
    ds_read_b64_tr_b16 v[80:81], v249 offset:14336
    ds_read_b64_tr_b16 v[82:83], v249 offset:14448
    ds_read_b64_tr_b16 v[84:85], v249 offset:14392
    ds_read_b64_tr_b16 v[86:87], v249 offset:14504
    s_waitcnt lgkmcnt(12)
    v_mfma_f32_32x32x16_bf16 v[16:31], v[88:91], v[132:135], v[16:31]
    v_mfma_f32_32x32x16_bf16 v[32:47], v[92:95], v[132:135], v[32:47]
    ds_read_b64_tr_b16 v[88:89], v249 offset:16128
    ds_read_b64_tr_b16 v[90:91], v249 offset:16240
    ds_read_b64_tr_b16 v[92:93], v249 offset:16184
    ds_read_b64_tr_b16 v[94:95], v249 offset:16296
    s_waitcnt lgkmcnt(12)
    v_mfma_f32_32x32x16_bf16 v[16:31], v[96:99], v[136:139], v[16:31]
    v_mfma_f32_32x32x16_bf16 v[32:47], v[100:103], v[136:139], v[32:47]
    ds_read_b64_tr_b16 v[96:97], v249 offset:17920
    ds_read_b64_tr_b16 v[98:99], v249 offset:18032
    ds_read_b64_tr_b16 v[100:101], v249 offset:17976
    ds_read_b64_tr_b16 v[102:103], v249 offset:18088
    s_waitcnt lgkmcnt(12)
    v_mfma_f32_32x32x16_bf16 v[16:31], v[104:107], v[140:143], v[16:31]
    v_mfma_f32_32x32x16_bf16 v[32:47], v[108:111], v[140:143], v[32:47]
    ds_read_b64_tr_b16 v[104:105], v249 offset:19712
    ds_read_b64_tr_b16 v[106:107], v249 offset:19824
    ds_read_b64_tr_b16 v[108:109], v249 offset:19768
    ds_read_b64_tr_b16 v[110:111], v249 offset:19880
    s_waitcnt lgkmcnt(12)
    v_mfma_f32_32x32x16_bf16 v[16:31], v[80:83], v[144:147], v[16:31]
    v_mfma_f32_32x32x16_bf16 v[32:47], v[84:87], v[144:147], v[32:47]
    ds_read_b64_tr_b16 v[80:81], v249 offset:21504
    ds_read_b64_tr_b16 v[82:83], v249 offset:21616
    ds_read_b64_tr_b16 v[84:85], v249 offset:21560
    ds_read_b64_tr_b16 v[86:87], v249 offset:21672
    s_waitcnt lgkmcnt(12)
    v_mfma_f32_32x32x16_bf16 v[16:31], v[88:91], v[148:151], v[16:31]
    v_mfma_f32_32x32x16_bf16 v[32:47], v[92:95], v[148:151], v[32:47]
    ds_read_b64_tr_b16 v[88:89], v249 offset:23296
    ds_read_b64_tr_b16 v[90:91], v249 offset:23408
    ds_read_b64_tr_b16 v[92:93], v249 offset:23352
    ds_read_b64_tr_b16 v[94:95], v249 offset:23464
    s_waitcnt lgkmcnt(12)
    v_mfma_f32_32x32x16_bf16 v[16:31], v[96:99], v[152:155], v[16:31]
    v_mfma_f32_32x32x16_bf16 v[32:47], v[100:103], v[152:155], v[32:47]
    ds_read_b64_tr_b16 v[96:97], v249 offset:25088
    ds_read_b64_tr_b16 v[98:99], v249 offset:25200
    ds_read_b64_tr_b16 v[100:101], v249 offset:25144
    ds_read_b64_tr_b16 v[102:103], v249 offset:25256
    s_waitcnt lgkmcnt(12)
    v_mfma_f32_32x32x16_bf16 v[16:31], v[104:107], v[156:159], v[16:31]
    v_mfma_f32_32x32x16_bf16 v[32:47], v[108:111], v[156:159], v[32:47]
    ds_read_b64_tr_b16 v[104:105], v249 offset:26880
    ds_read_b64_tr_b16 v[106:107], v249 offset:26992
    ds_read_b64_tr_b16 v[108:109], v249 offset:26936
    ds_read_b64_tr_b16 v[110:111], v249 offset:27048
    s_waitcnt lgkmcnt(12)
    v_mfma_f32_32x32x16_bf16 v[16:31], v[80:83], v[160:163], v[16:31]
    v_mfma_f32_32x32x16_bf16 v[32:47], v[84:87], v[160:163], v[32:47]
    ds_read_b64_tr_b16 v[80:81], v249 offset:28672
    ds_read_b64_tr_b16 v[82:83], v249 offset:28784
    ds_read_b64_tr_b16 v[84:85], v249 offset:28728
    ds_read_b64_tr_b16 v[86:87], v249 offset:28840
    s_waitcnt lgkmcnt(12)
    v_mfma_f32_32x32x16_bf16 v[16:31], v[88:91], v[164:167], v[16:31]
    v_mfma_f32_32x32x16_bf16 v[32:47], v[92:95], v[164:167], v[32:47]
    ds_read_b64_tr_b16 v[88:89], v249 offset:30464
    ds_read_b64_tr_b16 v[90:91], v249 offset:30576
    ds_read_b64_tr_b16 v[92:93], v249 offset:30520
    ds_read_b64_tr_b16 v[94:95], v249 offset:30632
    s_waitcnt lgkmcnt(12)
    v_mfma_f32_32x32x16_bf16 v[16:31], v[96:99], v[168:171], v[16:31]
    v_mfma_f32_32x32x16_bf16 v[32:47], v[100:103], v[168:171], v[32:47]
    ds_read_b64_tr_b16 v[96:97], v249 offset:32256
    ds_read_b64_tr_b16 v[98:99], v249 offset:32368
    ds_read_b64_tr_b16 v[100:101], v249 offset:32312
    ds_read_b64_tr_b16 v[102:103], v249 offset:32424
    s_waitcnt lgkmcnt(12)
    v_mfma_f32_32x32x16_bf16 v[16:31], v[104:107], v[172:175], v[16:31]
    v_mfma_f32_32x32x16_bf16 v[32:47], v[108:111], v[172:175], v[32:47]
    ds_read_b64_tr_b16 v[104:105], v249 offset:34048
    ds_read_b64_tr_b16 v[106:107], v249 offset:34160
    ds_read_b64_tr_b16 v[108:109], v249 offset:34104
    ds_read_b64_tr_b16 v[110:111], v249 offset:34216
    s_waitcnt lgkmcnt(12)
    v_mfma_f32_32x32x16_bf16 v[16:31], v[80:83], v[176:179], v[16:31]
    v_mfma_f32_32x32x16_bf16 v[32:47], v[84:87], v[176:179], v[32:47]
    ds_read_b64_tr_b16 v[80:81], v250 offset:0
    ds_read_b64_tr_b16 v[82:83], v250 offset:112
    ds_read_b64_tr_b16 v[84:85], v250 offset:56
    ds_read_b64_tr_b16 v[86:87], v250 offset:168
    s_waitcnt lgkmcnt(12)
    v_mfma_f32_32x32x16_bf16 v[16:31], v[88:91], v[180:183], v[16:31]
    v_mfma_f32_32x32x16_bf16 v[32:47], v[92:95], v[180:183], v[32:47]
    ds_read_b64_tr_b16 v[88:89], v250 offset:1792
    ds_read_b64_tr_b16 v[90:91], v250 offset:1904
    ds_read_b64_tr_b16 v[92:93], v250 offset:1848
    ds_read_b64_tr_b16 v[94:95], v250 offset:1960
    s_waitcnt lgkmcnt(12)
    v_mfma_f32_32x32x16_bf16 v[16:31], v[96:99], v[184:187], v[16:31]
    v_mfma_f32_32x32x16_bf16 v[32:47], v[100:103], v[184:187], v[32:47]
    ds_read_b64_tr_b16 v[96:97], v250 offset:3584
    ds_read_b64_tr_b16 v[98:99], v250 offset:3696
    ds_read_b64_tr_b16 v[100:101], v250 offset:3640
    ds_read_b64_tr_b16 v[102:103], v250 offset:3752
    s_waitcnt lgkmcnt(12)
    v_mfma_f32_32x32x16_bf16 v[16:31], v[104:107], v[188:191], v[16:31]
    v_mfma_f32_32x32x16_bf16 v[32:47], v[108:111], v[188:191], v[32:47]
    ds_read_b64_tr_b16 v[104:105], v250 offset:5376
    ds_read_b64_tr_b16 v[106:107], v250 offset:5488
    ds_read_b64_tr_b16 v[108:109], v250 offset:5432
    ds_read_b64_tr_b16 v[110:111], v250 offset:5544
    s_waitcnt lgkmcnt(12)
    v_mfma_f32_32x32x16_bf16 v[16:31], v[80:83], v[192:195], v[16:31]
    v_mfma_f32_32x32x16_bf16 v[32:47], v[84:87], v[192:195], v[32:47]
    ds_read_b64_tr_b16 v[80:81], v250 offset:7168
    ds_read_b64_tr_b16 v[82:83], v250 offset:7280
    ds_read_b64_tr_b16 v[84:85], v250 offset:7224
    ds_read_b64_tr_b16 v[86:87], v250 offset:7336
    s_waitcnt lgkmcnt(12)
    v_mfma_f32_32x32x16_bf16 v[16:31], v[88:91], v[196:199], v[16:31]
    v_mfma_f32_32x32x16_bf16 v[32:47], v[92:95], v[196:199], v[32:47]
    ds_read_b64_tr_b16 v[88:89], v250 offset:8960
    ds_read_b64_tr_b16 v[90:91], v250 offset:9072
    ds_read_b64_tr_b16 v[92:93], v250 offset:9016
    ds_read_b64_tr_b16 v[94:95], v250 offset:9128
    s_waitcnt lgkmcnt(12)
    v_mfma_f32_32x32x16_bf16 v[16:31], v[96:99], v[200:203], v[16:31]
    v_mfma_f32_32x32x16_bf16 v[32:47], v[100:103], v[200:203], v[32:47]
    ds_read_b64_tr_b16 v[96:97], v250 offset:10752
    ds_read_b64_tr_b16 v[98:99], v250 offset:10864
    ds_read_b64_tr_b16 v[100:101], v250 offset:10808
    ds_read_b64_tr_b16 v[102:103], v250 offset:10920
    s_waitcnt lgkmcnt(12)
    v_mfma_f32_32x32x16_bf16 v[16:31], v[104:107], v[204:207], v[16:31]
    v_mfma_f32_32x32x16_bf16 v[32:47], v[108:111], v[204:207], v[32:47]
    ds_read_b64_tr_b16 v[104:105], v250 offset:12544
    ds_read_b64_tr_b16 v[106:107], v250 offset:12656
    ds_read_b64_tr_b16 v[108:109], v250 offset:12600
    ds_read_b64_tr_b16 v[110:111], v250 offset:12712
    s_waitcnt lgkmcnt(12)
    v_mfma_f32_32x32x16_bf16 v[16:31], v[80:83], v[208:211], v[16:31]
    v_mfma_f32_32x32x16_bf16 v[32:47], v[84:87], v[208:211], v[32:47]
    s_waitcnt lgkmcnt(8)
    v_mfma_f32_32x32x16_bf16 v[16:31], v[88:91], v[212:215], v[16:31]
    v_mfma_f32_32x32x16_bf16 v[32:47], v[92:95], v[212:215], v[32:47]
    s_waitcnt lgkmcnt(4)
    v_mfma_f32_32x32x16_bf16 v[16:31], v[96:99], v[216:219], v[16:31]
    v_mfma_f32_32x32x16_bf16 v[32:47], v[100:103], v[216:219], v[32:47]
    s_waitcnt lgkmcnt(0)
    v_mfma_f32_32x32x16_bf16 v[16:31], v[104:107], v[220:223], v[16:31]
    v_mfma_f32_32x32x16_bf16 v[32:47], v[108:111], v[220:223], v[32:47]
L_lin_q:
    v_mov_b32 v3, 61456
    v_mov_b32 v4, 1
    s_mov_b64 exec, 1
    ds_add_u32 v3, v4
    s_mov_b64 exec, -1
    s_waitcnt vmcnt(0)
    v_mov_b32 v3, 61444
    v_mov_b32 v4, 1
    s_mov_b64 exec, 1
    ds_add_rtn_u32 v4, v3, v4
    s_mov_b64 exec, -1
    s_waitcnt lgkmcnt(0)
    v_readfirstlane_b32 s46, v4
    s_cmp_lg_u32 s46, 3
    s_cbranch_scc1 L_notlast_59
    s_cmp_lg_u32 s53, 0
    s_cbranch_scc1 L_nok_60
    s_mov_b32 s59, 262144
    v_mov_b32 v4, 0
L_npoll_61:
    buffer_load_dword v3, v4, s[96:99], 0 offen sc1
    s_waitcnt vmcnt(0)
    v_readfirstlane_b32 s53, v3
    s_sub_u32 s59, s59, 1
    s_cbranch_scc1 L_nok_60
    s_cmp_eq_u32 s53, 0
    s_cbranch_scc1 L_npoll_61
L_nok_60:
    s_mul_i32 s46, s22, 8
    s_add_u32 s46, s46, s23
    s_lshl_b32 s46, s46, 7
    s_add_u32 s46, s46, 10633216
    v_mov_b32 v3, s53
    v_mov_b32 v4, 0
    s_mov_b64 exec, 1
    buffer_store_dword v3, v4, s[12:15], s46 offen sc1
    s_mov_b64 exec, -1
L_notlast_59:
    s_nop 3
    s_mov_b32 s46, 0x3fb8aa3b
    s_mov_b32 s47, 0x3fb8aa3b
    s_mov_b32 s48, 0x358637bd
    s_mov_b32 s49, 0x358637bd
    v_pk_mul_f32 v[224:225], v[16:17], s[46:47]
    v_pk_mul_f32 v[226:227], v[18:19], s[46:47]
    v_pk_mul_f32 v[228:229], v[20:21], s[46:47]
    v_pk_mul_f32 v[230:231], v[22:23], s[46:47]
    v_pk_mul_f32 v[232:233], v[24:25], s[46:47]
    v_pk_mul_f32 v[234:235], v[26:27], s[46:47]
    v_pk_mul_f32 v[236:237], v[28:29], s[46:47]
    v_pk_mul_f32 v[238:239], v[30:31], s[46:47]
    v_exp_f32 v224, v224 clamp
    v_exp_f32 v225, v225 clamp
    v_exp_f32 v226, v226 clamp
    v_exp_f32 v227, v227 clamp
    v_exp_f32 v228, v228 clamp
    v_exp_f32 v229, v229 clamp
    v_exp_f32 v230, v230 clamp
    v_exp_f32 v231, v231 clamp
    v_exp_f32 v232, v232 clamp
    v_exp_f32 v233, v233 clamp
    v_exp_f32 v234, v234 clamp
    v_exp_f32 v235, v235 clamp
    v_exp_f32 v236, v236 clamp
    v_exp_f32 v237, v237 clamp
    v_exp_f32 v238, v238 clamp
    v_exp_f32 v239, v239 clamp
    v_max_f32 v16, 0, v16
    v_max_f32 v17, 0, v17
    v_max_f32 v18, 0, v18
    v_max_f32 v19, 0, v19
    v_max_f32 v20, 0, v20
    v_max_f32 v21, 0, v21
    v_max_f32 v22, 0, v22
    v_max_f32 v23, 0, v23
    v_max_f32 v24, 0, v24
    v_max_f32 v25, 0, v25
    v_max_f32 v26, 0, v26
    v_max_f32 v27, 0, v27
    v_max_f32 v28, 0, v28
    v_max_f32 v29, 0, v29
    v_max_f32 v30, 0, v30
    v_max_f32 v31, 0, v31
    v_pk_add_f32 v[224:225], v[224:225], s[48:49]
    v_pk_add_f32 v[226:227], v[226:227], s[48:49]
    v_pk_add_f32 v[228:229], v[228:229], s[48:49]
    v_pk_add_f32 v[230:231], v[230:231], s[48:49]
    v_pk_add_f32 v[232:233], v[232:233], s[48:49]
    v_pk_add_f32 v[234:235], v[234:235], s[48:49]
    v_pk_add_f32 v[236:237], v[236:237], s[48:49]
    v_pk_add_f32 v[238:239], v[238:239], s[48:49]
    v_pk_add_f32 v[16:17], v[16:17], v[224:225]
    v_pk_add_f32 v[18:19], v[18:19], v[226:227]
    v_pk_add_f32 v[20:21], v[20:21], v[228:229]
    v_pk_add_f32 v[22:23], v[22:23], v[230:231]
    v_pk_add_f32 v[24:25], v[24:25], v[232:233]
    v_pk_add_f32 v[26:27], v[26:27], v[234:235]
    v_pk_add_f32 v[28:29], v[28:29], v[236:237]
    v_pk_add_f32 v[30:31], v[30:31], v[238:239]
    v_cvt_pk_bf16_f32 v16, v16, v17
    v_cvt_pk_bf16_f32 v17, v18, v19
    v_cvt_pk_bf16_f32 v18, v20, v21
    v_cvt_pk_bf16_f32 v19, v22, v23
    v_cvt_pk_bf16_f32 v20, v24, v25
    v_cvt_pk_bf16_f32 v21, v26, v27
    v_cvt_pk_bf16_f32 v22, v28, v29
    v_cvt_pk_bf16_f32 v23, v30, v31
    v_cndmask_b32_e64 v22, v22, 0, s[44:45]
    v_cndmask_b32_e64 v23, v23, 0, s[44:45]
    s_mov_b32 s46, 0x3fb8aa3b
    s_mov_b32 s47, 0x3fb8aa3b
    s_mov_b32 s48, 0x358637bd
    s_mov_b32 s49, 0x358637bd
    v_pk_mul_f32 v[224:225], v[32:33], s[46:47]
    v_pk_mul_f32 v[226:227], v[34:35], s[46:47]
    v_pk_mul_f32 v[228:229], v[36:37], s[46:47]
    v_pk_mul_f32 v[230:231], v[38:39], s[46:47]
    v_pk_mul_f32 v[232:233], v[40:41], s[46:47]
    v_pk_mul_f32 v[234:235], v[42:43], s[46:47]
    v_pk_mul_f32 v[236:237], v[44:45], s[46:47]
    v_pk_mul_f32 v[238:239], v[46:47], s[46:47]
    v_exp_f32 v224, v224 clamp
    v_exp_f32 v225, v225 clamp
    v_exp_f32 v226, v226 clamp
    v_exp_f32 v227, v227 clamp
    v_exp_f32 v228, v228 clamp
    v_exp_f32 v229, v229 clamp
    v_exp_f32 v230, v230 clamp
    v_exp_f32 v231, v231 clamp
    v_exp_f32 v232, v232 clamp
    v_exp_f32 v233, v233 clamp
    v_exp_f32 v234, v234 clamp
    v_exp_f32 v235, v235 clamp
    v_exp_f32 v236, v236 clamp
    v_exp_f32 v237, v237 clamp
    v_exp_f32 v238, v238 clamp
    v_exp_f32 v239, v239 clamp
    v_max_f32 v32, 0, v32
    v_max_f32 v33, 0, v33
    v_max_f32 v34, 0, v34
    v_max_f32 v35, 0, v35
    v_max_f32 v36, 0, v36
    v_max_f32 v37, 0, v37
    v_max_f32 v38, 0, v38
    v_max_f32 v39, 0, v39
    v_max_f32 v40, 0, v40
    v_max_f32 v41, 0, v41
    v_max_f32 v42, 0, v42
    v_max_f32 v43, 0, v43
    v_max_f32 v44, 0, v44
    v_max_f32 v45, 0, v45
    v_max_f32 v46, 0, v46
    v_max_f32 v47, 0, v47
    v_pk_add_f32 v[224:225], v[224:225], s[48:49]
    v_pk_add_f32 v[226:227], v[226:227], s[48:49]
    v_pk_add_f32 v[228:229], v[228:229], s[48:49]
    v_pk_add_f32 v[230:231], v[230:231], s[48:49]
    v_pk_add_f32 v[232:233], v[232:233], s[48:49]
    v_pk_add_f32 v[234:235], v[234:235], s[48:49]
    v_pk_add_f32 v[236:237], v[236:237], s[48:49]
    v_pk_add_f32 v[238:239], v[238:239], s[48:49]
    v_pk_add_f32 v[32:33], v[32:33], v[224:225]
    v_pk_add_f32 v[34:35], v[34:35], v[226:227]
    v_pk_add_f32 v[36:37], v[36:37], v[228:229]
    v_pk_add_f32 v[38:39], v[38:39], v[230:231]
    v_pk_add_f32 v[40:41], v[40:41], v[232:233]
    v_pk_add_f32 v[42:43], v[42:43], v[234:235]
    v_pk_add_f32 v[44:45], v[44:45], v[236:237]
    v_pk_add_f32 v[46:47], v[46:47], v[238:239]
    v_cvt_pk_bf16_f32 v32, v32, v33
    v_cvt_pk_bf16_f32 v33, v34, v35
    v_cvt_pk_bf16_f32 v34, v36, v37
    v_cvt_pk_bf16_f32 v35, v38, v39
    v_cvt_pk_bf16_f32 v36, v40, v41
    v_cvt_pk_bf16_f32 v37, v42, v43
    v_cvt_pk_bf16_f32 v38, v44, v45
    v_cvt_pk_bf16_f32 v39, v46, v47
    v_cndmask_b32_e64 v38, v38, 0, s[44:45]
    v_cndmask_b32_e64 v39, v39, 0, s[44:45]
    s_mov_b32 s59, 2097152
    v_mov_b32 v3, 61456
L_cspin_62:
    ds_read_b32 v4, v3
    s_waitcnt lgkmcnt(0)
    v_readfirstlane_b32 s46, v4
    s_sub_u32 s59, s59, 1
    s_cbranch_scc1 L_cspun_63
    s_cmp_lt_u32 s46, 4
    s_cbranch_scc1 L_cspin_62
L_cspun_63:
    s_mul_i32 s46, s20, 28672
    v_add_u32 v5, s46, v2
    ds_write_b128 v5, v[16:19] offset:0
    ds_write_b128 v5, v[20:23] offset:1024
    ds_write_b128 v5, v[32:35] offset:2048
    ds_write_b128 v5, v[36:39] offset:3072
    s_cmp_lg_u32 s23, 0
    s_cbranch_scc1 L_nogate_64
    v_mul_f32 v224, 0xbfb8aa3b, v64
    v_exp_f32 v224, v224
    s_nop 0
    v_add_f32 v224, 1.0, v224
    v_rcp_f32 v224, v224
    s_lshl_b32 s46, s22, 2
    s_add_u32 s46, s46, s20
    s_lshl_b32 s46, s46, 7
    s_add_u32 s46, s46, 10571776
    v_and_b32 v3, 31, v1
    v_lshlrev_b32 v3, 2, v3
    buffer_store_dword v224, v3, s[12:15], s46 offen sc1
L_nogate_64:
    v_and_b32 v3, 31, v1
    v_lshrrev_b32 v4, 5, v1
    v_lshlrev_b32 v4, 2, v4
    v_sub_u32 v205, v3, v4
    v_cmp_le_i32_e64 s[60:61], 0, v205
    v_cmp_le_i32_e64 s[62:63], 1, v205
    v_cmp_le_i32_e64 s[64:65], 2, v205
    v_cmp_le_i32_e64 s[66:67], 3, v205
    v_cmp_le_i32_e64 s[68:69], 8, v205
    v_cmp_le_i32_e64 s[70:71], 9, v205
    v_cmp_le_i32_e64 s[72:73], 10, v205
    v_cmp_le_i32_e64 s[74:75], 11, v205
    v_cmp_le_i32_e64 s[76:77], 16, v205
    v_cmp_le_i32_e64 s[78:79], 17, v205
    v_cmp_le_i32_e64 s[80:81], 18, v205
    v_cmp_le_i32_e64 s[82:83], 19, v205
    v_cmp_le_i32_e64 s[84:85], 24, v205
    v_cmp_le_i32_e64 s[86:87], 25, v205
    v_cmp_le_i32_e64 s[88:89], 26, v205
    v_cmp_le_i32_e64 s[90:91], 27, v205
    v_mov_b32 v3, 0xffff
    v_mov_b32 v4, 0xffff0000
    v_cndmask_b32_e64 v224, 0, v3, s[60:61]
    v_cndmask_b32_e64 v5, 0, v4, s[62:63]
    v_or_b32 v224, v224, v5
    v_cndmask_b32_e64 v225, 0, v3, s[64:65]
    v_cndmask_b32_e64 v5, 0, v4, s[66:67]
    v_or_b32 v225, v225, v5
    v_cndmask_b32_e64 v226, 0, v3, s[68:69]
    v_cndmask_b32_e64 v5, 0, v4, s[70:71]
    v_or_b32 v226, v226, v5
    v_cndmask_b32_e64 v227, 0, v3, s[72:73]
    v_cndmask_b32_e64 v5, 0, v4, s[74:75]
    v_or_b32 v227, v227, v5
    v_cndmask_b32_e64 v228, 0, v3, s[76:77]
    v_cndmask_b32_e64 v5, 0, v4, s[78:79]
    v_or_b32 v228, v228, v5
    v_cndmask_b32_e64 v229, 0, v3, s[80:81]
    v_cndmask_b32_e64 v5, 0, v4, s[82:83]
    v_or_b32 v229, v229, v5
    v_cndmask_b32_e64 v230, 0, v3, s[84:85]
    v_cndmask_b32_e64 v5, 0, v4, s[86:87]
    v_or_b32 v230, v230, v5
    v_cndmask_b32_e64 v231, 0, v3, s[88:89]
    v_cndmask_b32_e64 v5, 0, v4, s[90:91]
    v_or_b32 v231, v231, v5
    s_mov_b32 s92, 0x3e8b97f6
    s_mov_b32 s93, 0x3e8b97f6
    s_lshl_b32 s47, s20, 12
    s_add_u32 s47, s47, 114688
    v_add_u32 v200, s47, v2
    s_waitcnt lgkmcnt(0)
    s_barrier
    s_lshl_b32 s46, s20, 11
    v_add_u32 v3, s46, v2
    ds_read_b128 v[160:163], v3 offset:36864
    ds_read_b128 v[164:167], v3 offset:37888
    s_branch L_attn
L_lin_gate:
    s_lshl_b32 s46, s43, 7
    v_add_u32 v251, s46, v253
    s_add_u32 s43, s43, 1
    s_cmp_eq_u32 s43, 7
    s_cselect_b32 s43, 0, s43
    ds_read_b64_tr_b16 v[80:81], v249 offset:0
    ds_read_b64_tr_b16 v[82:83], v249 offset:112
    ds_read_b64_tr_b16 v[84:85], v249 offset:56
    ds_read_b64_tr_b16 v[86:87], v249 offset:168
    ds_read_b128 v[88:91], v251 offset:0
    ds_read_b64_tr_b16 v[92:93], v249 offset:1792
    ds_read_b64_tr_b16 v[94:95], v249 offset:1904
    ds_read_b64_tr_b16 v[96:97], v249 offset:1848
    ds_read_b64_tr_b16 v[98:99], v249 offset:1960
    ds_read_b128 v[100:103], v251 offset:32
    ds_read_b64_tr_b16 v[48:49], v249 offset:3584
    ds_read_b64_tr_b16 v[50:51], v249 offset:3696
    ds_read_b64_tr_b16 v[52:53], v249 offset:3640
    ds_read_b64_tr_b16 v[54:55], v249 offset:3752
    ds_read_b128 v[56:59], v251 offset:64
    s_waitcnt lgkmcnt(10)
    v_mfma_f32_32x32x16_bf16 v[16:31], v[80:83], v[112:115], 0
    v_mfma_f32_32x32x16_bf16 v[32:47], v[84:87], v[112:115], 0
    v_mfma_f32_32x32x16_bf16 v[64:79], v[88:91], v[112:115], 0
    ds_read_b64_tr_b16 v[80:81], v249 offset:5376
    ds_read_b64_tr_b16 v[82:83], v249 offset:5488
    ds_read_b64_tr_b16 v[84:85], v249 offset:5432
    ds_read_b64_tr_b16 v[86:87], v249 offset:5544
    ds_read_b128 v[88:91], v251 offset:96
    s_waitcnt lgkmcnt(10)
    v_mfma_f32_32x32x16_bf16 v[16:31], v[92:95], v[116:119], v[16:31]
    v_mfma_f32_32x32x16_bf16 v[32:47], v[96:99], v[116:119], v[32:47]
    v_mfma_f32_32x32x16_bf16 v[64:79], v[100:103], v[116:119], v[64:79]
    s_lshl_b32 s46, s43, 7
    v_add_u32 v252, s46, v253
    s_add_u32 s43, s43, 1
    s_cmp_eq_u32 s43, 7
    s_cselect_b32 s43, 0, s43
    ds_read_b64_tr_b16 v[92:93], v249 offset:7168
    ds_read_b64_tr_b16 v[94:95], v249 offset:7280
    ds_read_b64_tr_b16 v[96:97], v249 offset:7224
    ds_read_b64_tr_b16 v[98:99], v249 offset:7336
    ds_read_b128 v[100:103], v252 offset:0
    s_waitcnt lgkmcnt(10)
    v_mfma_f32_32x32x16_bf16 v[16:31], v[48:51], v[120:123], v[16:31]
    v_mfma_f32_32x32x16_bf16 v[32:47], v[52:55], v[120:123], v[32:47]
    v_mfma_f32_32x32x16_bf16 v[64:79], v[56:59], v[120:123], v[64:79]
    ds_read_b64_tr_b16 v[48:49], v249 offset:8960
    ds_read_b64_tr_b16 v[50:51], v249 offset:9072
    ds_read_b64_tr_b16 v[52:53], v249 offset:9016
    ds_read_b64_tr_b16 v[54:55], v249 offset:9128
    ds_read_b128 v[56:59], v252 offset:32
    s_waitcnt lgkmcnt(10)
    v_mfma_f32_32x32x16_bf16 v[16:31], v[80:83], v[124:127], v[16:31]
    v_mfma_f32_32x32x16_bf16 v[32:47], v[84:87], v[124:127], v[32:47]
    v_mfma_f32_32x32x16_bf16 v[64:79], v[88:91], v[124:127], v[64:79]
    ds_read_b64_tr_b16 v[80:81], v249 offset:10752
    ds_read_b64_tr_b16 v[82:83], v249 offset:10864
    ds_read_b64_tr_b16 v[84:85], v249 offset:10808
    ds_read_b64_tr_b16 v[86:87], v249 offset:10920
    ds_read_b128 v[88:91], v252 offset:64
    s_waitcnt lgkmcnt(10)
    v_mfma_f32_32x32x16_bf16 v[16:31], v[92:95], v[128:131], v[16:31]
    v_mfma_f32_32x32x16_bf16 v[32:47], v[96:99], v[128:131], v[32:47]
    v_mfma_f32_32x32x16_bf16 v[64:79], v[100:103], v[128:131], v[64:79]
    ds_read_b64_tr_b16 v[92:93], v249 offset:12544
    ds_read_b64_tr_b16 v[94:95], v249 offset:12656
    ds_read_b64_tr_b16 v[96:97], v249 offset:12600
    ds_read_b64_tr_b16 v[98:99], v249 offset:12712
    ds_read_b128 v[100:103], v252 offset:96
    s_waitcnt lgkmcnt(10)
    v_mfma_f32_32x32x16_bf16 v[16:31], v[48:51], v[132:135], v[16:31]
    v_mfma_f32_32x32x16_bf16 v[32:47], v[52:55], v[132:135], v[32:47]
    v_mfma_f32_32x32x16_bf16 v[64:79], v[56:59], v[132:135], v[64:79]
    s_lshl_b32 s46, s43, 7
    v_add_u32 v251, s46, v253
    s_add_u32 s43, s43, 1
    s_cmp_eq_u32 s43, 7
    s_cselect_b32 s43, 0, s43
    ds_read_b64_tr_b16 v[48:49], v249 offset:14336
    ds_read_b64_tr_b16 v[50:51], v249 offset:14448
    ds_read_b64_tr_b16 v[52:53], v249 offset:14392
    ds_read_b64_tr_b16 v[54:55], v249 offset:14504
    ds_read_b128 v[56:59], v251 offset:0
    s_waitcnt lgkmcnt(10)
    v_mfma_f32_32x32x16_bf16 v[16:31], v[80:83], v[136:139], v[16:31]
    v_mfma_f32_32x32x16_bf16 v[32:47], v[84:87], v[136:139], v[32:47]
    v_mfma_f32_32x32x16_bf16 v[64:79], v[88:91], v[136:139], v[64:79]
    ds_read_b64_tr_b16 v[80:81], v249 offset:16128
    ds_read_b64_tr_b16 v[82:83], v249 offset:16240
    ds_read_b64_tr_b16 v[84:85], v249 offset:16184
    ds_read_b64_tr_b16 v[86:87], v249 offset:16296
    ds_read_b128 v[88:91], v251 offset:32
    s_waitcnt lgkmcnt(10)
    v_mfma_f32_32x32x16_bf16 v[16:31], v[92:95], v[140:143], v[16:31]
    v_mfma_f32_32x32x16_bf16 v[32:47], v[96:99], v[140:143], v[32:47]
    v_mfma_f32_32x32x16_bf16 v[64:79], v[100:103], v[140:143], v[64:79]
    ds_read_b64_tr_b16 v[92:93], v249 offset:17920
    ds_read_b64_tr_b16 v[94:95], v249 offset:18032
    ds_read_b64_tr_b16 v[96:97], v249 offset:17976
    ds_read_b64_tr_b16 v[98:99], v249 offset:18088
    ds_read_b128 v[100:103], v251 offset:64
    s_waitcnt lgkmcnt(10)
    v_mfma_f32_32x32x16_bf16 v[16:31], v[48:51], v[144:147], v[16:31]
    v_mfma_f32_32x32x16_bf16 v[32:47], v[52:55], v[144:147], v[32:47]
    v_mfma_f32_32x32x16_bf16 v[64:79], v[56:59], v[144:147], v[64:79]
    ds_read_b64_tr_b16 v[48:49], v249 offset:19712
    ds_read_b64_tr_b16 v[50:51], v249 offset:19824
    ds_read_b64_tr_b16 v[52:53], v249 offset:19768
    ds_read_b64_tr_b16 v[54:55], v249 offset:19880
    ds_read_b128 v[56:59], v251 offset:96
    s_waitcnt lgkmcnt(10)
    v_mfma_f32_32x32x16_bf16 v[16:31], v[80:83], v[148:151], v[16:31]
    v_mfma_f32_32x32x16_bf16 v[32:47], v[84:87], v[148:151], v[32:47]
    v_mfma_f32_32x32x16_bf16 v[64:79], v[88:91], v[148:151], v[64:79]
    s_lshl_b32 s46, s43, 7
    v_add_u32 v252, s46, v253
    s_add_u32 s43, s43, 1
    s_cmp_eq_u32 s43, 7
    s_cselect_b32 s43, 0, s43
    ds_read_b64_tr_b16 v[80:81], v249 offset:21504
    ds_read_b64_tr_b16 v[82:83], v249 offset:21616
    ds_read_b64_tr_b16 v[84:85], v249 offset:21560
    ds_read_b64_tr_b16 v[86:87], v249 offset:21672
    ds_read_b128 v[88:91], v252 offset:0
    s_waitcnt lgkmcnt(10)
    v_mfma_f32_32x32x16_bf16 v[16:31], v[92:95], v[152:155], v[16:31]
    v_mfma_f32_32x32x16_bf16 v[32:47], v[96:99], v[152:155], v[32:47]
    v_mfma_f32_32x32x16_bf16 v[64:79], v[100:103], v[152:155], v[64:79]
    ds_read_b64_tr_b16 v[92:93], v249 offset:23296
    ds_read_b64_tr_b16 v[94:95], v249 offset:23408
    ds_read_b64_tr_b16 v[96:97], v249 offset:23352
    ds_read_b64_tr_b16 v[98:99], v249 offset:23464
    ds_read_b128 v[100:103], v252 offset:32
    s_waitcnt lgkmcnt(10)
    v_mfma_f32_32x32x16_bf16 v[16:31], v[48:51], v[156:159], v[16:31]
    v_mfma_f32_32x32x16_bf16 v[32:47], v[52:55], v[156:159], v[32:47]
    v_mfma_f32_32x32x16_bf16 v[64:79], v[56:59], v[156:159], v[64:79]
    ds_read_b64_tr_b16 v[48:49], v249 offset:25088
    ds_read_b64_tr_b16 v[50:51], v249 offset:25200
    ds_read_b64_tr_b16 v[52:53], v249 offset:25144
    ds_read_b64_tr_b16 v[54:55], v249 offset:25256
    ds_read_b128 v[56:59], v252 offset:64
    s_waitcnt lgkmcnt(10)
    v_mfma_f32_32x32x16_bf16 v[16:31], v[80:83], v[160:163], v[16:31]
    v_mfma_f32_32x32x16_bf16 v[32:47], v[84:87], v[160:163], v[32:47]
    v_mfma_f32_32x32x16_bf16 v[64:79], v[88:91], v[160:163], v[64:79]
    ds_read_b64_tr_b16 v[80:81], v249 offset:26880
    ds_read_b64_tr_b16 v[82:83], v249 offset:26992
    ds_read_b64_tr_b16 v[84:85], v249 offset:26936
    ds_read_b64_tr_b16 v[86:87], v249 offset:27048
    ds_read_b128 v[88:91], v252 offset:96
    s_waitcnt lgkmcnt(10)
    v_mfma_f32_32x32x16_bf16 v[16:31], v[92:95], v[164:167], v[16:31]
    v_mfma_f32_32x32x16_bf16 v[32:47], v[96:99], v[164:167], v[32:47]
    v_mfma_f32_32x32x16_bf16 v[64:79], v[100:103], v[164:167], v[64:79]
    s_lshl_b32 s46, s43, 7
    v_add_u32 v251, s46, v253
    s_add_u32 s43, s43, 1
    s_cmp_eq_u32 s43, 7
    s_cselect_b32 s43, 0, s43
    ds_read_b64_tr_b16 v[92:93], v249 offset:28672
    ds_read_b64_tr_b16 v[94:95], v249 offset:28784
    ds_read_b64_tr_b16 v[96:97], v249 offset:28728
    ds_read_b64_tr_b16 v[98:99], v249 offset:28840
    ds_read_b128 v[100:103], v251 offset:0
    s_waitcnt lgkmcnt(10)
    v_mfma_f32_32x32x16_bf16 v[16:31], v[48:51], v[168:171], v[16:31]
    v_mfma_f32_32x32x16_bf16 v[32:47], v[52:55], v[168:171], v[32:47]
    v_mfma_f32_32x32x16_bf16 v[64:79], v[56:59], v[168:171], v[64:79]
    ds_read_b64_tr_b16 v[48:49], v249 offset:30464
    ds_read_b64_tr_b16 v[50:51], v249 offset:30576
    ds_read_b64_tr_b16 v[52:53], v249 offset:30520
    ds_read_b64_tr_b16 v[54:55], v249 offset:30632
    ds_read_b128 v[56:59], v251 offset:32
    s_waitcnt lgkmcnt(10)
    v_mfma_f32_32x32x16_bf16 v[16:31], v[80:83], v[172:175], v[16:31]
    v_mfma_f32_32x32x16_bf16 v[32:47], v[84:87], v[172:175], v[32:47]
    v_mfma_f32_32x32x16_bf16 v[64:79], v[88:91], v[172:175], v[64:79]
    ds_read_b64_tr_b16 v[80:81], v249 offset:32256
    ds_read_b64_tr_b16 v[82:83], v249 offset:32368
    ds_read_b64_tr_b16 v[84:85], v249 offset:32312
    ds_read_b64_tr_b16 v[86:87], v249 offset:32424
    ds_read_b128 v[88:91], v251 offset:64
    s_waitcnt lgkmcnt(10)
    v_mfma_f32_32x32x16_bf16 v[16:31], v[92:95], v[176:179], v[16:31]
    v_mfma_f32_32x32x16_bf16 v[32:47], v[96:99], v[176:179], v[32:47]
    v_mfma_f32_32x32x16_bf16 v[64:79], v[100:103], v[176:179], v[64:79]
    ds_read_b64_tr_b16 v[92:93], v249 offset:34048
    ds_read_b64_tr_b16 v[94:95], v249 offset:34160
    ds_read_b64_tr_b16 v[96:97], v249 offset:34104
    ds_read_b64_tr_b16 v[98:99], v249 offset:34216
    ds_read_b128 v[100:103], v251 offset:96
    s_waitcnt lgkmcnt(10)
    v_mfma_f32_32x32x16_bf16 v[16:31], v[48:51], v[180:183], v[16:31]
    v_mfma_f32_32x32x16_bf16 v[32:47], v[52:55], v[180:183], v[32:47]
    v_mfma_f32_32x32x16_bf16 v[64:79], v[56:59], v[180:183], v[64:79]
    s_lshl_b32 s46, s43, 7
    v_add_u32 v252, s46, v253
    s_add_u32 s43, s43, 1
    s_cmp_eq_u32 s43, 7
    s_cselect_b32 s43, 0, s43
    ds_read_b64_tr_b16 v[48:49], v250 offset:0
    ds_read_b64_tr_b16 v[50:51], v250 offset:112
    ds_read_b64_tr_b16 v[52:53], v250 offset:56
    ds_read_b64_tr_b16 v[54:55], v250 offset:168
    ds_read_b128 v[56:59], v252 offset:0
    s_waitcnt lgkmcnt(10)
    v_mfma_f32_32x32x16_bf16 v[16:31], v[80:83], v[184:187], v[16:31]
    v_mfma_f32_32x32x16_bf16 v[32:47], v[84:87], v[184:187], v[32:47]
    v_mfma_f32_32x32x16_bf16 v[64:79], v[88:91], v[184:187], v[64:79]
    ds_read_b64_tr_b16 v[80:81], v250 offset:1792
    ds_read_b64_tr_b16 v[82:83], v250 offset:1904
    ds_read_b64_tr_b16 v[84:85], v250 offset:1848
    ds_read_b64_tr_b16 v[86:87], v250 offset:1960
    ds_read_b128 v[88:91], v252 offset:32
    s_waitcnt lgkmcnt(10)
    v_mfma_f32_32x32x16_bf16 v[16:31], v[92:95], v[188:191], v[16:31]
    v_mfma_f32_32x32x16_bf16 v[32:47], v[96:99], v[188:191], v[32:47]
    v_mfma_f32_32x32x16_bf16 v[64:79], v[100:103], v[188:191], v[64:79]
    ds_read_b64_tr_b16 v[92:93], v250 offset:3584
    ds_read_b64_tr_b16 v[94:95], v250 offset:3696
    ds_read_b64_tr_b16 v[96:97], v250 offset:3640
    ds_read_b64_tr_b16 v[98:99], v250 offset:3752
    ds_read_b128 v[100:103], v252 offset:64
    s_waitcnt lgkmcnt(10)
    v_mfma_f32_32x32x16_bf16 v[16:31], v[48:51], v[192:195], v[16:31]
    v_mfma_f32_32x32x16_bf16 v[32:47], v[52:55], v[192:195], v[32:47]
    v_mfma_f32_32x32x16_bf16 v[64:79], v[56:59], v[192:195], v[64:79]
    ds_read_b64_tr_b16 v[48:49], v250 offset:5376
    ds_read_b64_tr_b16 v[50:51], v250 offset:5488
    ds_read_b64_tr_b16 v[52:53], v250 offset:5432
    ds_read_b64_tr_b16 v[54:55], v250 offset:5544
    ds_read_b128 v[56:59], v252 offset:96
    s_waitcnt lgkmcnt(10)
    v_mfma_f32_32x32x16_bf16 v[16:31], v[80:83], v[196:199], v[16:31]
    v_mfma_f32_32x32x16_bf16 v[32:47], v[84:87], v[196:199], v[32:47]
    v_mfma_f32_32x32x16_bf16 v[64:79], v[88:91], v[196:199], v[64:79]
    s_lshl_b32 s46, s43, 7
    v_add_u32 v251, s46, v253
    s_add_u32 s43, s43, 1
    s_cmp_eq_u32 s43, 7
    s_cselect_b32 s43, 0, s43
    ds_read_b64_tr_b16 v[80:81], v250 offset:7168
    ds_read_b64_tr_b16 v[82:83], v250 offset:7280
    ds_read_b64_tr_b16 v[84:85], v250 offset:7224
    ds_read_b64_tr_b16 v[86:87], v250 offset:7336
    ds_read_b128 v[88:91], v251 offset:0
    s_waitcnt lgkmcnt(10)
    v_mfma_f32_32x32x16_bf16 v[16:31], v[92:95], v[200:203], v[16:31]
    v_mfma_f32_32x32x16_bf16 v[32:47], v[96:99], v[200:203], v[32:47]
    v_mfma_f32_32x32x16_bf16 v[64:79], v[100:103], v[200:203], v[64:79]
    ds_read_b64_tr_b16 v[92:93], v250 offset:8960
    ds_read_b64_tr_b16 v[94:95], v250 offset:9072
    ds_read_b64_tr_b16 v[96:97], v250 offset:9016
    ds_read_b64_tr_b16 v[98:99], v250 offset:9128
    ds_read_b128 v[100:103], v251 offset:32
    s_waitcnt lgkmcnt(10)
    v_mfma_f32_32x32x16_bf16 v[16:31], v[48:51], v[204:207], v[16:31]
    v_mfma_f32_32x32x16_bf16 v[32:47], v[52:55], v[204:207], v[32:47]
    v_mfma_f32_32x32x16_bf16 v[64:79], v[56:59], v[204:207], v[64:79]
    ds_read_b64_tr_b16 v[48:49], v250 offset:10752
    ds_read_b64_tr_b16 v[50:51], v250 offset:10864
    ds_read_b64_tr_b16 v[52:53], v250 offset:10808
    ds_read_b64_tr_b16 v[54:55], v250 offset:10920
    ds_read_b128 v[56:59], v251 offset:64
    s_waitcnt lgkmcnt(10)
    v_mfma_f32_32x32x16_bf16 v[16:31], v[80:83], v[208:211], v[16:31]
    v_mfma_f32_32x32x16_bf16 v[32:47], v[84:87], v[208:211], v[32:47]
    v_mfma_f32_32x32x16_bf16 v[64:79], v[88:91], v[208:211], v[64:79]
    ds_read_b64_tr_b16 v[80:81], v250 offset:12544
    ds_read_b64_tr_b16 v[82:83], v250 offset:12656
    ds_read_b64_tr_b16 v[84:85], v250 offset:12600
    ds_read_b64_tr_b16 v[86:87], v250 offset:12712
    ds_read_b128 v[88:91], v251 offset:96
    s_waitcnt lgkmcnt(10)
    v_mfma_f32_32x32x16_bf16 v[16:31], v[92:95], v[212:215], v[16:31]
    v_mfma_f32_32x32x16_bf16 v[32:47], v[96:99], v[212:215], v[32:47]
    v_mfma_f32_32x32x16_bf16 v[64:79], v[100:103], v[212:215], v[64:79]
    s_waitcnt lgkmcnt(5)
    v_mfma_f32_32x32x16_bf16 v[16:31], v[48:51], v[216:219], v[16:31]
    v_mfma_f32_32x32x16_bf16 v[32:47], v[52:55], v[216:219], v[32:47]
    v_mfma_f32_32x32x16_bf16 v[64:79], v[56:59], v[216:219], v[64:79]
    s_waitcnt lgkmcnt(0)
    v_mfma_f32_32x32x16_bf16 v[16:31], v[80:83], v[220:223], v[16:31]
    v_mfma_f32_32x32x16_bf16 v[32:47], v[84:87], v[220:223], v[32:47]
    v_mfma_f32_32x32x16_bf16 v[64:79], v[88:91], v[220:223], v[64:79]
    s_branch L_lin_q
.section .rodata,"a"
.p2align 6
.amdhsa_kernel gated_mix__linear_attn_block__sliding_block__prompt_kernel
  .amdhsa_next_free_vgpr 256
  .amdhsa_next_free_sgpr 102
  .amdhsa_accum_offset 256
  .amdhsa_group_segment_fixed_size 0
  .amdhsa_kernarg_size 80
  .amdhsa_user_sgpr_count 2
  .amdhsa_user_sgpr_kernarg_segment_ptr 1
  .amdhsa_system_sgpr_workgroup_id_x 1
.end_amdhsa_kernel
```
